```python
import torch

def _softmax(x, axis=-1):
    return torch.softmax(x, dim=axis)
def _gelu(x):
    return torch.nn.functional.gelu(x, approximate="tanh")
def _silu(x):
    return torch.nn.functional.silu(x)
def _sigmoid(x):
    return torch.sigmoid(x)
def _layernorm(x, axis=-1, eps=1e-5):
    m = x.mean(dim=axis, keepdim=True)
    v = x.var(dim=axis, keepdim=True, unbiased=False)
    return (x - m) / torch.sqrt(v + eps)
def _scatter_add(tgt, idx, src, axis=0):
    return tgt.clone().index_add_(axis, idx, src)
def _segment_sum(src, seg, n):
    out = torch.zeros((n,) + src.shape[1:], dtype=src.dtype)
    return out.index_add_(0, seg, src)
def _pad(x, pw):
    flat = tuple(v for pair in reversed(pw) for v in pair)
    return torch.nn.functional.pad(x, flat)

kernel_name = 'concat_heads__gqa_block_cached__mha_block_cached__near_ridge'

def setup_inputs():

    _w = (lambda a: (lambda t: t.to(torch.bfloat16) if t.is_floating_point() else t)(torch.as_tensor(a)))
    def _A_setup():
        B, Sq, D = 8, 128, 640
        Hq, Hkv, Sk, Dh = 32, 32, 512, 128
        assert Hq % Hkv == 0, (Hq, Hkv)
        return {
            "x": _w((lambda *s: torch.randn(*s, dtype=torch.bfloat16) * 0.8)(B, Sq, D)),
            "k_cache": _w((lambda *s: torch.randn(*s, dtype=torch.bfloat16) * 0.8)(B, Hkv, Sk, Dh)),
            "v_cache": _w((lambda *s: torch.randn(*s, dtype=torch.bfloat16) * 0.05)(B, Hkv, Sk, Dh)),
            "wq": _w((lambda *s: torch.randn(*s, dtype=torch.bfloat16) * 0.8)(D, Hq * Dh) * (D ** -0.5)),
            "wo": _w((lambda *s: torch.randn(*s, dtype=torch.bfloat16) * 0.05)(Hq * Dh, D) * ((Hq * Dh) ** -0.5)),
        }
    _A_in = _A_setup()

    def _B_setup():
        B, Sq, D = 8, 128, 640
        H, Sk, Dh = 32, 512, 128
        return {
            "x": _w((lambda *s: torch.randn(*s, dtype=torch.bfloat16) * 0.8)(B, Sq, D)),
            "k_cache": _w((lambda *s: torch.randn(*s, dtype=torch.bfloat16) * 0.8)(B, H, Sk, Dh)),
            "v_cache": _w((lambda *s: torch.randn(*s, dtype=torch.bfloat16) * 0.05)(B, H, Sk, Dh)),
            "wq": _w((lambda *s: torch.randn(*s, dtype=torch.bfloat16) * 0.8)(D, H * Dh) * (D ** -0.5)),
            "wo": _w((lambda *s: torch.randn(*s, dtype=torch.bfloat16) * 0.05)(H * Dh, D) * ((H * Dh) ** -0.5)),
        }
    _B_in = _B_setup()

    return {
        "A_x": _A_in["x"],
        "A_k_cache": _A_in["k_cache"],
        "A_v_cache": _A_in["v_cache"],
        "A_wq": _A_in["wq"],
        "A_wo": _A_in["wo"],
        "B_x": _B_in["x"],
        "B_k_cache": _B_in["k_cache"],
        "B_v_cache": _B_in["v_cache"],
        "B_wq": _B_in["wq"],
        "B_wo": _B_in["wo"],
    }

def reference(A_x, A_k_cache, A_v_cache, A_wq, A_wo, B_x, B_k_cache, B_v_cache, B_wq, B_wo):
    def _A_ref(x, k_cache, v_cache, wq, wo):
        B, Sq, D = x.shape
        Hq, Dh = 32, 128
        Hkv = k_cache.shape[1]
        rep = Hq // Hkv
        q = (lambda x, *d: x.permute(*d))((x @ wq).reshape(B, Sq, Hq, Dh), 0, 2, 1, 3)
        k = (lambda x, n, axis: torch.repeat_interleave(x, n, dim=axis))(k_cache, rep, axis=1)
        v = (lambda x, n, axis: torch.repeat_interleave(x, n, dim=axis))(v_cache, rep, axis=1)
        scores = torch.einsum("bhqd,bhkd->bhqk", q, k) * (Dh ** -0.5)
        p = _softmax(scores, axis=-1)
        o = torch.einsum("bhqk,bhkd->bhqd", p, v)
        return (lambda x, *d: x.permute(*d))(o, 0, 2, 1, 3).reshape(B, Sq, Hq * Dh) @ wo

    def _B_ref(x, k_cache, v_cache, wq, wo):
        B, Sq, D = x.shape
        H, Dh = 32, 128
        q = (lambda x, *d: x.permute(*d))((x @ wq).reshape(B, Sq, H, Dh), 0, 2, 1, 3)
        scores = torch.einsum("bhqd,bhkd->bhqk", q, k_cache) * (Dh ** -0.5)
        p = _softmax(scores, axis=-1)
        o = torch.einsum("bhqk,bhkd->bhqd", p, v_cache)
        return (lambda x, *d: x.permute(*d))(o, 0, 2, 1, 3).reshape(B, Sq, H * Dh) @ wo

    a = _A_ref(A_x, A_k_cache, A_v_cache, A_wq, A_wo)
    b = _B_ref(B_x, B_k_cache, B_v_cache, B_wq, B_wo)
    return torch.concatenate([a, b], axis=-1)
```

```asm
; @launch kernel=attn_kernel grid=(512,1,1) block=(256,1,1) lds=81920
; @launch kernel=oproj_kernel grid=(256,1,1) block=(512,1,1) lds=163840
.amdgcn_target "amdgcn-amd-amdhsa--gfx950"
.text
.globl attn_kernel
.p2align 8
.type attn_kernel,@function
attn_kernel:
    s_cmp_ge_u32 s2, 512
    s_cbranch_scc1 attn_done
    s_load_dwordx16 s[48:63], s[0:1], 0
    s_load_dwordx8 s[64:71], s[0:1], 64
    s_load_dwordx2 s[72:73], s[0:1], 96
    s_and_b32 s31, s2, 7
    s_bfe_u32 s32, s2, 0x50003
    s_lshr_b32 s33, s2, 8
    s_and_b32 s35, s32, 7
    s_lshr_b32 s36, s32, 3
    s_lshl_b32 s37, s36, 3
    s_add_u32 s37, s37, s31
    s_and_b32 s34, s31, 3
    s_lshl_b32 s38, s33, 3
    s_add_u32 s38, s38, s35
    s_lshr_b32 s39, s31, 2
    v_and_b32 v1, 63, v0
    v_lshrrev_b32 v2, 6, v0
    s_nop 0
    v_readfirstlane_b32 s24, v2
    v_lshrrev_b32 v3, 4, v1
    v_and_b32 v4, 15, v1
    v_lshrrev_b32 v5, 5, v1
    v_and_b32 v6, 31, v1
    v_bfe_u32 v7, v1, 2, 2
    v_and_b32 v8, 3, v1
    v_and_b32 v9, 1, v3
    v_mov_b32 v15, 0
    s_cmp_ge_u32 s2, 256
    s_cbranch_scc1 PR_1
    s_setprio 2
PR_1:
    v_lshl_or_b32 v10, v3, 2, 0
    v_xor_b32 v10, v4, v10
    v_lshlrev_b32 v10, 4, v10
    v_lshl_add_u32 v216, v3, 8, v10
    v_lshl_or_b32 v10, v3, 2, 1
    v_xor_b32 v10, v4, v10
    v_lshlrev_b32 v10, 4, v10
    v_lshl_add_u32 v217, v3, 8, v10
    v_lshl_or_b32 v10, v3, 2, 2
    v_xor_b32 v10, v4, v10
    v_lshlrev_b32 v10, 4, v10
    v_lshl_add_u32 v218, v3, 8, v10
    v_lshl_or_b32 v10, v3, 2, 3
    v_xor_b32 v10, v4, v10
    v_lshlrev_b32 v10, 4, v10
    v_lshl_add_u32 v219, v3, 8, v10
    v_lshl_or_b32 v10, v2, 1, 0
    v_and_b32 v10, 3, v10
    v_lshl_or_b32 v10, v3, 2, v10
    v_xor_b32 v10, v4, v10
    v_lshlrev_b32 v10, 4, v10
    v_lshl_add_u32 v10, v3, 13, v10
    v_add_u32 v144, 0, v10
    v_lshl_or_b32 v10, v2, 1, 1
    v_and_b32 v10, 3, v10
    v_lshl_or_b32 v10, v3, 2, v10
    v_xor_b32 v10, v4, v10
    v_lshlrev_b32 v10, 4, v10
    v_lshl_add_u32 v10, v3, 13, v10
    v_add_u32 v145, 31744, v10
    v_lshrrev_b32 v11, 3, v1
    v_mul_u32_u24 v11, 0x500, v11
    v_and_b32 v12, 7, v1
    v_add_u32 v10, 0, v3
    v_xor_b32 v10, v12, v10
    v_lshl_add_u32 v10, v10, 4, v11
    v_add_u32 v146, 0, v10
    v_add_u32 v10, 4, v3
    v_xor_b32 v10, v12, v10
    v_lshl_add_u32 v10, v10, 4, v11
    v_add_u32 v147, 9216, v10
    v_add_u32 v10, 0, v3
    v_xor_b32 v10, v12, v10
    v_lshl_add_u32 v10, v10, 4, v11
    v_add_u32 v148, 18432, v10
    v_add_u32 v10, 4, v3
    v_xor_b32 v10, v12, v10
    v_lshl_add_u32 v10, v10, 4, v11
    v_add_u32 v149, 27648, v10
    s_waitcnt lgkmcnt(0)
    s_cmp_eq_u32 s33, 1
    s_cselect_b64 s[40:41], s[58:59], s[48:49]
    s_cselect_b64 s[42:43], s[60:61], s[50:51]
    s_cselect_b64 s[44:45], s[62:63], s[52:53]
    s_cselect_b64 s[46:47], s[64:65], s[54:55]
    s_cmp_eq_u32 s39, 1
    s_cselect_b64 s[74:75], s[66:67], s[56:57]
    s_mul_i32 s29, s35, 163840
    s_add_u32 s4, s40, s29
    s_addc_u32 s5, s41, 0
    s_and_b32 s5, s5, 0xffff
    s_mov_b32 s6, 163840
    s_mov_b32 s7, 0x00020000
    s_lshl_b32 s93, s37, 8
    s_sub_u32 s30, 5242880, s93
    s_add_u32 s12, s46, s93
    s_addc_u32 s13, s47, 0
    s_and_b32 s13, s13, 0xffff
    s_mov_b32 s14, s30
    s_mov_b32 s15, 0x00020000
    s_lshl_b32 s29, s35, 5
    s_add_u32 s29, s29, s37
    s_lshl_b32 s29, s29, 17
    s_add_u32 s20, s42, s29
    s_addc_u32 s21, s43, 0
    s_and_b32 s21, s21, 0xffff
    s_mov_b32 s22, 131072
    s_mov_b32 s23, 0x00020000
    s_add_u32 s96, s44, s29
    s_addc_u32 s97, s45, 0
    s_and_b32 s97, s97, 0xffff
    s_mov_b32 s98, 131072
    s_mov_b32 s99, 0x00020000
    s_lshl_b32 s26, s24, 11
    s_lshl_b32 s27, s24, 16
    s_lshl_b32 s92, s24, 12
    s_add_u32 s28, s92, 32768
    s_mul_i32 s25, s24, 40960
    s_add_u32 m0, s28, 0
    s_add_u32 s29, s25, 0
    buffer_load_dwordx4 v146, s[4:7], s29 offen offset:0 lds
    buffer_load_dwordx4 v147, s[4:7], s29 offen offset:1024 lds
    buffer_load_dwordx4 v148, s[4:7], s29 offen offset:2048 lds
    buffer_load_dwordx4 v149, s[4:7], s29 offen offset:3072 lds
    s_add_u32 m0, s26, 0
    s_add_u32 s29, s27, 0
    buffer_load_dwordx4 v144, s[12:15], s29 offen offset:0 lds
    buffer_load_dwordx4 v145, s[12:15], s29 offen offset:1024 lds
    s_add_u32 m0, s26, 8192
    s_add_u32 s29, s27, 262144
    buffer_load_dwordx4 v144, s[12:15], s29 offen offset:0 lds
    buffer_load_dwordx4 v145, s[12:15], s29 offen offset:1024 lds
    s_add_u32 m0, s28, 16384
    s_add_u32 s29, s25, 128
    buffer_load_dwordx4 v146, s[4:7], s29 offen offset:0 lds
    buffer_load_dwordx4 v147, s[4:7], s29 offen offset:1024 lds
    buffer_load_dwordx4 v148, s[4:7], s29 offen offset:2048 lds
    buffer_load_dwordx4 v149, s[4:7], s29 offen offset:3072 lds
    s_add_u32 m0, s26, 16384
    s_add_u32 s29, s27, 524288
    buffer_load_dwordx4 v144, s[12:15], s29 offen offset:0 lds
    buffer_load_dwordx4 v145, s[12:15], s29 offen offset:1024 lds
    s_add_u32 m0, s26, 24576
    s_add_u32 s29, s27, 786432
    buffer_load_dwordx4 v144, s[12:15], s29 offen offset:0 lds
    buffer_load_dwordx4 v145, s[12:15], s29 offen offset:1024 lds
    s_add_u32 m0, s92, 65536
    s_add_u32 s29, s92, 0
    buffer_load_dwordx4 v216, s[20:23], s29 offen offset:0 lds
    buffer_load_dwordx4 v217, s[20:23], s29 offen offset:1024 lds
    buffer_load_dwordx4 v218, s[20:23], s29 offen offset:2048 lds
    buffer_load_dwordx4 v219, s[20:23], s29 offen offset:3072 lds
    v_bfe_u32 v10, v6, 1, 3
    v_xor_b32 v10, v5, v10
    v_lshlrev_b32 v10, 4, v10
    v_lshl_add_u32 v10, v6, 7, v10
    v_lshl_add_u32 v10, v2, 12, v10
    v_add_u32 v10, 32768, v10
    v_xor_b32 v150, 0, v10
    v_xor_b32 v151, 32, v10
    v_xor_b32 v152, 64, v10
    v_xor_b32 v153, 96, v10
    v_and_b32 v10, 1, v8
    v_lshl_or_b32 v10, v9, 1, v10
    v_lshrrev_b32 v11, 1, v8
    v_lshl_or_b32 v12, v5, 1, 0
    v_xor_b32 v13, v10, v12
    v_lshlrev_b32 v13, 4, v13
    v_lshl_add_u32 v13, v11, 3, v13
    v_lshl_add_u32 v14, v12, 2, v7
    v_lshl_add_u32 v13, v14, 8, v13
    v_lshl_add_u32 v13, v7, 6, v13
    v_xor_b32 v208, 0, v13
    v_xor_b32 v210, 64, v13
    v_xor_b32 v212, 128, v13
    v_xor_b32 v214, 192, v13
    v_lshl_or_b32 v12, v5, 1, 1
    v_xor_b32 v13, v10, v12
    v_lshlrev_b32 v13, 4, v13
    v_lshl_add_u32 v13, v11, 3, v13
    v_lshl_add_u32 v14, v12, 2, v7
    v_lshl_add_u32 v13, v14, 8, v13
    v_lshl_add_u32 v13, v7, 6, v13
    v_xor_b32 v209, 0, v13
    v_xor_b32 v211, 64, v13
    v_xor_b32 v213, 128, v13
    v_xor_b32 v215, 192, v13
    v_and_b32 v10, 3, v6
    v_bfe_u32 v11, v6, 2, 2
    v_lshl_or_b32 v10, v10, 2, v11
    v_xor_b32 v10, v5, v10
    v_lshlrev_b32 v10, 4, v10
    v_lshl_add_u32 v10, v6, 8, v10
    v_xor_b32 v200, 0, v10
    v_xor_b32 v201, 32, v10
    v_xor_b32 v202, 64, v10
    v_xor_b32 v203, 96, v10
    v_xor_b32 v204, 128, v10
    v_xor_b32 v205, 160, v10
    v_xor_b32 v206, 192, v10
    v_xor_b32 v207, 224, v10
    v_lshl_add_u32 v10, v2, 1, v9
    v_lshlrev_b32 v10, 17, v10
    v_lshl_add_u32 v11, v5, 4, v4
    v_lshl_add_u32 v229, v11, 4, v10
    s_waitcnt vmcnt(16)
    ds_read_b128 v[112:115], v150 offset:0
    ds_read_b128 v[116:119], v151 offset:0
    ds_read_b128 v[120:123], v152 offset:0
    ds_read_b128 v[124:127], v153 offset:0
    s_waitcnt lgkmcnt(0)
    s_waitcnt vmcnt(14)
    s_barrier
    ds_read_b64_tr_b16 v[176:177], v208 offset:0
    ds_read_b64_tr_b16 v[178:179], v209 offset:0
    ds_read_b64_tr_b16 v[180:181], v210 offset:0
    ds_read_b64_tr_b16 v[182:183], v211 offset:0
    ds_read_b64_tr_b16 v[184:185], v212 offset:0
    ds_read_b64_tr_b16 v[186:187], v213 offset:0
    ds_read_b64_tr_b16 v[188:189], v214 offset:0
    ds_read_b64_tr_b16 v[190:191], v215 offset:0
    s_add_u32 m0, s28, 0
    s_add_u32 s29, s25, 256
    buffer_load_dwordx4 v146, s[4:7], s29 offen offset:0 lds
    buffer_load_dwordx4 v147, s[4:7], s29 offen offset:1024 lds
    buffer_load_dwordx4 v148, s[4:7], s29 offen offset:2048 lds
    buffer_load_dwordx4 v149, s[4:7], s29 offen offset:3072 lds
    ds_read_b64_tr_b16 v[192:193], v208 offset:4096
    ds_read_b64_tr_b16 v[194:195], v209 offset:4096
    s_waitcnt lgkmcnt(8)
    v_mfma_f32_32x32x16_bf16 v[48:63], v[176:179], v[112:115], 0
    ds_read_b64_tr_b16 v[196:197], v210 offset:4096
    ds_read_b64_tr_b16 v[198:199], v211 offset:4096
    s_waitcnt lgkmcnt(8)
    v_mfma_f32_32x32x16_bf16 v[64:79], v[180:183], v[112:115], 0
    ds_read_b64_tr_b16 v[176:177], v212 offset:4096
    ds_read_b64_tr_b16 v[178:179], v213 offset:4096
    s_waitcnt lgkmcnt(8)
    v_mfma_f32_32x32x16_bf16 v[80:95], v[184:187], v[112:115], 0
    ds_read_b64_tr_b16 v[180:181], v214 offset:4096
    ds_read_b64_tr_b16 v[182:183], v215 offset:4096
    s_waitcnt lgkmcnt(8)
    v_mfma_f32_32x32x16_bf16 v[96:111], v[188:191], v[112:115], 0
    s_waitcnt vmcnt(16)
    s_barrier
    ds_read_b64_tr_b16 v[184:185], v208 offset:8192
    ds_read_b64_tr_b16 v[186:187], v209 offset:8192
    s_waitcnt lgkmcnt(8)
    v_mfma_f32_32x32x16_bf16 v[48:63], v[192:195], v[116:119], v[48:63]
    ds_read_b64_tr_b16 v[188:189], v210 offset:8192
    ds_read_b64_tr_b16 v[190:191], v211 offset:8192
    s_waitcnt lgkmcnt(8)
    v_mfma_f32_32x32x16_bf16 v[64:79], v[196:199], v[116:119], v[64:79]
    ds_read_b64_tr_b16 v[192:193], v212 offset:8192
    ds_read_b64_tr_b16 v[194:195], v213 offset:8192
    s_waitcnt lgkmcnt(8)
    v_mfma_f32_32x32x16_bf16 v[80:95], v[176:179], v[116:119], v[80:95]
    s_waitcnt vmcnt(12)
    ds_read_b128 v[128:131], v150 offset:16384
    ds_read_b128 v[132:135], v151 offset:16384
    ds_read_b128 v[136:139], v152 offset:16384
    ds_read_b128 v[140:143], v153 offset:16384
    ds_read_b64_tr_b16 v[196:197], v214 offset:8192
    ds_read_b64_tr_b16 v[198:199], v215 offset:8192
    s_waitcnt lgkmcnt(12)
    v_mfma_f32_32x32x16_bf16 v[96:111], v[180:183], v[116:119], v[96:111]
    ds_read_b64_tr_b16 v[176:177], v208 offset:12288
    ds_read_b64_tr_b16 v[178:179], v209 offset:12288
    s_waitcnt lgkmcnt(12)
    v_mfma_f32_32x32x16_bf16 v[48:63], v[184:187], v[120:123], v[48:63]
    ds_read_b64_tr_b16 v[180:181], v210 offset:12288
    ds_read_b64_tr_b16 v[182:183], v211 offset:12288
    s_waitcnt lgkmcnt(12)
    v_mfma_f32_32x32x16_bf16 v[64:79], v[188:191], v[120:123], v[64:79]
    ds_read_b64_tr_b16 v[184:185], v212 offset:12288
    ds_read_b64_tr_b16 v[186:187], v213 offset:12288
    s_waitcnt lgkmcnt(12)
    v_mfma_f32_32x32x16_bf16 v[80:95], v[192:195], v[120:123], v[80:95]
    ds_read_b64_tr_b16 v[188:189], v214 offset:12288
    ds_read_b64_tr_b16 v[190:191], v215 offset:12288
    s_waitcnt lgkmcnt(8)
    v_mfma_f32_32x32x16_bf16 v[96:111], v[196:199], v[120:123], v[96:111]
    s_waitcnt vmcnt(10)
    s_barrier
    s_add_u32 m0, s26, 0
    s_add_u32 s29, s27, 1048576
    buffer_load_dwordx4 v144, s[12:15], s29 offen offset:0 lds
    buffer_load_dwordx4 v145, s[12:15], s29 offen offset:1024 lds
    ds_read_b64_tr_b16 v[192:193], v208 offset:16384
    ds_read_b64_tr_b16 v[194:195], v209 offset:16384
    s_waitcnt lgkmcnt(8)
    v_mfma_f32_32x32x16_bf16 v[48:63], v[176:179], v[124:127], v[48:63]
    ds_read_b64_tr_b16 v[196:197], v210 offset:16384
    ds_read_b64_tr_b16 v[198:199], v211 offset:16384
    s_waitcnt lgkmcnt(8)
    v_mfma_f32_32x32x16_bf16 v[64:79], v[180:183], v[124:127], v[64:79]
    ds_read_b64_tr_b16 v[176:177], v212 offset:16384
    ds_read_b64_tr_b16 v[178:179], v213 offset:16384
    s_waitcnt lgkmcnt(8)
    v_mfma_f32_32x32x16_bf16 v[80:95], v[184:187], v[124:127], v[80:95]
    ds_read_b64_tr_b16 v[180:181], v214 offset:16384
    ds_read_b64_tr_b16 v[182:183], v215 offset:16384
    s_waitcnt lgkmcnt(8)
    v_mfma_f32_32x32x16_bf16 v[96:111], v[188:191], v[124:127], v[96:111]
    s_add_u32 m0, s28, 16384
    s_add_u32 s29, s25, 384
    buffer_load_dwordx4 v146, s[4:7], s29 offen offset:0 lds
    buffer_load_dwordx4 v147, s[4:7], s29 offen offset:1024 lds
    buffer_load_dwordx4 v148, s[4:7], s29 offen offset:2048 lds
    buffer_load_dwordx4 v149, s[4:7], s29 offen offset:3072 lds
    ds_read_b64_tr_b16 v[184:185], v208 offset:20480
    ds_read_b64_tr_b16 v[186:187], v209 offset:20480
    s_waitcnt lgkmcnt(8)
    v_mfma_f32_32x32x16_bf16 v[48:63], v[192:195], v[128:131], v[48:63]
    ds_read_b64_tr_b16 v[188:189], v210 offset:20480
    ds_read_b64_tr_b16 v[190:191], v211 offset:20480
    s_waitcnt lgkmcnt(8)
    v_mfma_f32_32x32x16_bf16 v[64:79], v[196:199], v[128:131], v[64:79]
    ds_read_b64_tr_b16 v[192:193], v212 offset:20480
    ds_read_b64_tr_b16 v[194:195], v213 offset:20480
    s_waitcnt lgkmcnt(8)
    v_mfma_f32_32x32x16_bf16 v[80:95], v[176:179], v[128:131], v[80:95]
    ds_read_b64_tr_b16 v[196:197], v214 offset:20480
    ds_read_b64_tr_b16 v[198:199], v215 offset:20480
    s_waitcnt lgkmcnt(8)
    v_mfma_f32_32x32x16_bf16 v[96:111], v[180:183], v[128:131], v[96:111]
    s_waitcnt vmcnt(14)
    s_barrier
    s_add_u32 m0, s26, 8192
    s_add_u32 s29, s27, 1310720
    buffer_load_dwordx4 v144, s[12:15], s29 offen offset:0 lds
    buffer_load_dwordx4 v145, s[12:15], s29 offen offset:1024 lds
    ds_read_b64_tr_b16 v[176:177], v208 offset:24576
    ds_read_b64_tr_b16 v[178:179], v209 offset:24576
    s_waitcnt lgkmcnt(8)
    v_mfma_f32_32x32x16_bf16 v[48:63], v[184:187], v[132:135], v[48:63]
    ds_read_b64_tr_b16 v[180:181], v210 offset:24576
    ds_read_b64_tr_b16 v[182:183], v211 offset:24576
    s_waitcnt lgkmcnt(8)
    v_mfma_f32_32x32x16_bf16 v[64:79], v[188:191], v[132:135], v[64:79]
    ds_read_b64_tr_b16 v[184:185], v212 offset:24576
    ds_read_b64_tr_b16 v[186:187], v213 offset:24576
    s_waitcnt lgkmcnt(8)
    v_mfma_f32_32x32x16_bf16 v[80:95], v[192:195], v[132:135], v[80:95]
    s_waitcnt vmcnt(8)
    ds_read_b128 v[112:115], v150 offset:0
    ds_read_b128 v[116:119], v151 offset:0
    ds_read_b128 v[120:123], v152 offset:0
    ds_read_b128 v[124:127], v153 offset:0
    ds_read_b64_tr_b16 v[188:189], v214 offset:24576
    ds_read_b64_tr_b16 v[190:191], v215 offset:24576
    s_waitcnt lgkmcnt(12)
    v_mfma_f32_32x32x16_bf16 v[96:111], v[196:199], v[132:135], v[96:111]
    ds_read_b64_tr_b16 v[192:193], v208 offset:28672
    ds_read_b64_tr_b16 v[194:195], v209 offset:28672
    s_waitcnt lgkmcnt(12)
    v_mfma_f32_32x32x16_bf16 v[48:63], v[176:179], v[136:139], v[48:63]
    ds_read_b64_tr_b16 v[196:197], v210 offset:28672
    ds_read_b64_tr_b16 v[198:199], v211 offset:28672
    s_waitcnt lgkmcnt(12)
    v_mfma_f32_32x32x16_bf16 v[64:79], v[180:183], v[136:139], v[64:79]
    ds_read_b64_tr_b16 v[176:177], v212 offset:28672
    ds_read_b64_tr_b16 v[178:179], v213 offset:28672
    s_waitcnt lgkmcnt(12)
    v_mfma_f32_32x32x16_bf16 v[80:95], v[184:187], v[136:139], v[80:95]
    ds_read_b64_tr_b16 v[180:181], v214 offset:28672
    ds_read_b64_tr_b16 v[182:183], v215 offset:28672
    s_waitcnt lgkmcnt(8)
    v_mfma_f32_32x32x16_bf16 v[96:111], v[188:191], v[136:139], v[96:111]
    s_waitcnt vmcnt(6)
    s_barrier
    s_add_u32 m0, s26, 16384
    s_add_u32 s29, s27, 1572864
    buffer_load_dwordx4 v144, s[12:15], s29 offen offset:0 lds
    buffer_load_dwordx4 v145, s[12:15], s29 offen offset:1024 lds
    ds_read_b64_tr_b16 v[184:185], v208 offset:0
    ds_read_b64_tr_b16 v[186:187], v209 offset:0
    s_waitcnt lgkmcnt(8)
    v_mfma_f32_32x32x16_bf16 v[48:63], v[192:195], v[140:143], v[48:63]
    ds_read_b64_tr_b16 v[188:189], v210 offset:0
    ds_read_b64_tr_b16 v[190:191], v211 offset:0
    s_waitcnt lgkmcnt(8)
    v_mfma_f32_32x32x16_bf16 v[64:79], v[196:199], v[140:143], v[64:79]
    ds_read_b64_tr_b16 v[192:193], v212 offset:0
    ds_read_b64_tr_b16 v[194:195], v213 offset:0
    s_waitcnt lgkmcnt(8)
    v_mfma_f32_32x32x16_bf16 v[80:95], v[176:179], v[140:143], v[80:95]
    ds_read_b64_tr_b16 v[196:197], v214 offset:0
    ds_read_b64_tr_b16 v[198:199], v215 offset:0
    s_waitcnt lgkmcnt(8)
    v_mfma_f32_32x32x16_bf16 v[96:111], v[180:183], v[140:143], v[96:111]
    s_add_u32 m0, s28, 0
    s_add_u32 s29, s25, 512
    buffer_load_dwordx4 v146, s[4:7], s29 offen offset:0 lds
    buffer_load_dwordx4 v147, s[4:7], s29 offen offset:1024 lds
    buffer_load_dwordx4 v148, s[4:7], s29 offen offset:2048 lds
    buffer_load_dwordx4 v149, s[4:7], s29 offen offset:3072 lds
    ds_read_b64_tr_b16 v[176:177], v208 offset:4096
    ds_read_b64_tr_b16 v[178:179], v209 offset:4096
    s_waitcnt lgkmcnt(8)
    v_mfma_f32_32x32x16_bf16 v[48:63], v[184:187], v[112:115], v[48:63]
    ds_read_b64_tr_b16 v[180:181], v210 offset:4096
    ds_read_b64_tr_b16 v[182:183], v211 offset:4096
    s_waitcnt lgkmcnt(8)
    v_mfma_f32_32x32x16_bf16 v[64:79], v[188:191], v[112:115], v[64:79]
    ds_read_b64_tr_b16 v[184:185], v212 offset:4096
    ds_read_b64_tr_b16 v[186:187], v213 offset:4096
    s_waitcnt lgkmcnt(8)
    v_mfma_f32_32x32x16_bf16 v[80:95], v[192:195], v[112:115], v[80:95]
    ds_read_b64_tr_b16 v[188:189], v214 offset:4096
    ds_read_b64_tr_b16 v[190:191], v215 offset:4096
    s_waitcnt lgkmcnt(8)
    v_mfma_f32_32x32x16_bf16 v[96:111], v[196:199], v[112:115], v[96:111]
    s_waitcnt vmcnt(6)
    s_barrier
    s_add_u32 m0, s26, 24576
    s_add_u32 s29, s27, 1835008
    buffer_load_dwordx4 v144, s[12:15], s29 offen offset:0 lds
    buffer_load_dwordx4 v145, s[12:15], s29 offen offset:1024 lds
    ds_read_b64_tr_b16 v[192:193], v208 offset:8192
    ds_read_b64_tr_b16 v[194:195], v209 offset:8192
    s_waitcnt lgkmcnt(8)
    v_mfma_f32_32x32x16_bf16 v[48:63], v[176:179], v[116:119], v[48:63]
    ds_read_b64_tr_b16 v[196:197], v210 offset:8192
    ds_read_b64_tr_b16 v[198:199], v211 offset:8192
    s_waitcnt lgkmcnt(8)
    v_mfma_f32_32x32x16_bf16 v[64:79], v[180:183], v[116:119], v[64:79]
    ds_read_b64_tr_b16 v[176:177], v212 offset:8192
    ds_read_b64_tr_b16 v[178:179], v213 offset:8192
    s_waitcnt lgkmcnt(8)
    v_mfma_f32_32x32x16_bf16 v[80:95], v[184:187], v[116:119], v[80:95]
    ds_read_b128 v[128:131], v150 offset:16384
    ds_read_b128 v[132:135], v151 offset:16384
    ds_read_b128 v[136:139], v152 offset:16384
    ds_read_b128 v[140:143], v153 offset:16384
    ds_read_b64_tr_b16 v[180:181], v214 offset:8192
    ds_read_b64_tr_b16 v[182:183], v215 offset:8192
    s_waitcnt lgkmcnt(12)
    v_mfma_f32_32x32x16_bf16 v[96:111], v[188:191], v[116:119], v[96:111]
    ds_read_b64_tr_b16 v[184:185], v208 offset:12288
    ds_read_b64_tr_b16 v[186:187], v209 offset:12288
    s_waitcnt lgkmcnt(12)
    v_mfma_f32_32x32x16_bf16 v[48:63], v[192:195], v[120:123], v[48:63]
    ds_read_b64_tr_b16 v[188:189], v210 offset:12288
    ds_read_b64_tr_b16 v[190:191], v211 offset:12288
    s_waitcnt lgkmcnt(12)
    v_mfma_f32_32x32x16_bf16 v[64:79], v[196:199], v[120:123], v[64:79]
    ds_read_b64_tr_b16 v[192:193], v212 offset:12288
    ds_read_b64_tr_b16 v[194:195], v213 offset:12288
    s_waitcnt lgkmcnt(12)
    v_mfma_f32_32x32x16_bf16 v[80:95], v[176:179], v[120:123], v[80:95]
    ds_read_b64_tr_b16 v[196:197], v214 offset:12288
    ds_read_b64_tr_b16 v[198:199], v215 offset:12288
    s_waitcnt lgkmcnt(8)
    v_mfma_f32_32x32x16_bf16 v[96:111], v[180:183], v[120:123], v[96:111]
    s_waitcnt vmcnt(6)
    s_barrier
    s_add_u32 m0, s26, 0
    s_add_u32 s29, s27, 2097152
    buffer_load_dwordx4 v144, s[12:15], s29 offen offset:0 lds
    buffer_load_dwordx4 v145, s[12:15], s29 offen offset:1024 lds
    ds_read_b64_tr_b16 v[176:177], v208 offset:16384
    ds_read_b64_tr_b16 v[178:179], v209 offset:16384
    s_waitcnt lgkmcnt(8)
    v_mfma_f32_32x32x16_bf16 v[48:63], v[184:187], v[124:127], v[48:63]
    ds_read_b64_tr_b16 v[180:181], v210 offset:16384
    ds_read_b64_tr_b16 v[182:183], v211 offset:16384
    s_waitcnt lgkmcnt(8)
    v_mfma_f32_32x32x16_bf16 v[64:79], v[188:191], v[124:127], v[64:79]
    ds_read_b64_tr_b16 v[184:185], v212 offset:16384
    ds_read_b64_tr_b16 v[186:187], v213 offset:16384
    s_waitcnt lgkmcnt(8)
    v_mfma_f32_32x32x16_bf16 v[80:95], v[192:195], v[124:127], v[80:95]
    ds_read_b64_tr_b16 v[188:189], v214 offset:16384
    ds_read_b64_tr_b16 v[190:191], v215 offset:16384
    s_waitcnt lgkmcnt(8)
    v_mfma_f32_32x32x16_bf16 v[96:111], v[196:199], v[124:127], v[96:111]
    s_add_u32 m0, s28, 16384
    s_add_u32 s29, s25, 640
    buffer_load_dwordx4 v146, s[4:7], s29 offen offset:0 lds
    buffer_load_dwordx4 v147, s[4:7], s29 offen offset:1024 lds
    buffer_load_dwordx4 v148, s[4:7], s29 offen offset:2048 lds
    buffer_load_dwordx4 v149, s[4:7], s29 offen offset:3072 lds
    ds_read_b64_tr_b16 v[192:193], v208 offset:20480
    ds_read_b64_tr_b16 v[194:195], v209 offset:20480
    s_waitcnt lgkmcnt(8)
    v_mfma_f32_32x32x16_bf16 v[48:63], v[176:179], v[128:131], v[48:63]
    ds_read_b64_tr_b16 v[196:197], v210 offset:20480
    ds_read_b64_tr_b16 v[198:199], v211 offset:20480
    s_waitcnt lgkmcnt(8)
    v_mfma_f32_32x32x16_bf16 v[64:79], v[180:183], v[128:131], v[64:79]
    ds_read_b64_tr_b16 v[176:177], v212 offset:20480
    ds_read_b64_tr_b16 v[178:179], v213 offset:20480
    s_waitcnt lgkmcnt(8)
    v_mfma_f32_32x32x16_bf16 v[80:95], v[184:187], v[128:131], v[80:95]
    ds_read_b64_tr_b16 v[180:181], v214 offset:20480
    ds_read_b64_tr_b16 v[182:183], v215 offset:20480
    s_waitcnt lgkmcnt(8)
    v_mfma_f32_32x32x16_bf16 v[96:111], v[188:191], v[128:131], v[96:111]
    s_waitcnt vmcnt(6)
    s_barrier
    s_add_u32 m0, s26, 8192
    s_add_u32 s29, s27, 2359296
    buffer_load_dwordx4 v144, s[12:15], s29 offen offset:0 lds
    buffer_load_dwordx4 v145, s[12:15], s29 offen offset:1024 lds
    ds_read_b64_tr_b16 v[184:185], v208 offset:24576
    ds_read_b64_tr_b16 v[186:187], v209 offset:24576
    s_waitcnt lgkmcnt(8)
    v_mfma_f32_32x32x16_bf16 v[48:63], v[192:195], v[132:135], v[48:63]
    ds_read_b64_tr_b16 v[188:189], v210 offset:24576
    ds_read_b64_tr_b16 v[190:191], v211 offset:24576
    s_waitcnt lgkmcnt(8)
    v_mfma_f32_32x32x16_bf16 v[64:79], v[196:199], v[132:135], v[64:79]
    ds_read_b64_tr_b16 v[192:193], v212 offset:24576
    ds_read_b64_tr_b16 v[194:195], v213 offset:24576
    s_waitcnt lgkmcnt(8)
    v_mfma_f32_32x32x16_bf16 v[80:95], v[176:179], v[132:135], v[80:95]
    ds_read_b128 v[112:115], v150 offset:0
    ds_read_b128 v[116:119], v151 offset:0
    ds_read_b128 v[120:123], v152 offset:0
    ds_read_b128 v[124:127], v153 offset:0
    ds_read_b64_tr_b16 v[196:197], v214 offset:24576
    ds_read_b64_tr_b16 v[198:199], v215 offset:24576
    s_waitcnt lgkmcnt(12)
    v_mfma_f32_32x32x16_bf16 v[96:111], v[180:183], v[132:135], v[96:111]
    ds_read_b64_tr_b16 v[176:177], v208 offset:28672
    ds_read_b64_tr_b16 v[178:179], v209 offset:28672
    s_waitcnt lgkmcnt(12)
    v_mfma_f32_32x32x16_bf16 v[48:63], v[184:187], v[136:139], v[48:63]
    ds_read_b64_tr_b16 v[180:181], v210 offset:28672
    ds_read_b64_tr_b16 v[182:183], v211 offset:28672
    s_waitcnt lgkmcnt(12)
    v_mfma_f32_32x32x16_bf16 v[64:79], v[188:191], v[136:139], v[64:79]
    ds_read_b64_tr_b16 v[184:185], v212 offset:28672
    ds_read_b64_tr_b16 v[186:187], v213 offset:28672
    s_waitcnt lgkmcnt(12)
    v_mfma_f32_32x32x16_bf16 v[80:95], v[192:195], v[136:139], v[80:95]
    ds_read_b64_tr_b16 v[188:189], v214 offset:28672
    ds_read_b64_tr_b16 v[190:191], v215 offset:28672
    s_waitcnt lgkmcnt(8)
    v_mfma_f32_32x32x16_bf16 v[96:111], v[196:199], v[136:139], v[96:111]
    s_waitcnt vmcnt(6)
    s_barrier
    s_add_u32 m0, s26, 16384
    s_add_u32 s29, s27, 2621440
    buffer_load_dwordx4 v144, s[12:15], s29 offen offset:0 lds
    buffer_load_dwordx4 v145, s[12:15], s29 offen offset:1024 lds
    ds_read_b64_tr_b16 v[192:193], v208 offset:0
    ds_read_b64_tr_b16 v[194:195], v209 offset:0
    s_waitcnt lgkmcnt(8)
    v_mfma_f32_32x32x16_bf16 v[48:63], v[176:179], v[140:143], v[48:63]
    ds_read_b64_tr_b16 v[196:197], v210 offset:0
    ds_read_b64_tr_b16 v[198:199], v211 offset:0
    s_waitcnt lgkmcnt(8)
    v_mfma_f32_32x32x16_bf16 v[64:79], v[180:183], v[140:143], v[64:79]
    ds_read_b64_tr_b16 v[176:177], v212 offset:0
    ds_read_b64_tr_b16 v[178:179], v213 offset:0
    s_waitcnt lgkmcnt(8)
    v_mfma_f32_32x32x16_bf16 v[80:95], v[184:187], v[140:143], v[80:95]
    ds_read_b64_tr_b16 v[180:181], v214 offset:0
    ds_read_b64_tr_b16 v[182:183], v215 offset:0
    s_waitcnt lgkmcnt(8)
    v_mfma_f32_32x32x16_bf16 v[96:111], v[188:191], v[140:143], v[96:111]
    s_add_u32 m0, s28, 0
    s_add_u32 s29, s25, 768
    buffer_load_dwordx4 v146, s[4:7], s29 offen offset:0 lds
    buffer_load_dwordx4 v147, s[4:7], s29 offen offset:1024 lds
    buffer_load_dwordx4 v148, s[4:7], s29 offen offset:2048 lds
    buffer_load_dwordx4 v149, s[4:7], s29 offen offset:3072 lds
    ds_read_b64_tr_b16 v[184:185], v208 offset:4096
    ds_read_b64_tr_b16 v[186:187], v209 offset:4096
    s_waitcnt lgkmcnt(8)
    v_mfma_f32_32x32x16_bf16 v[48:63], v[192:195], v[112:115], v[48:63]
    ds_read_b64_tr_b16 v[188:189], v210 offset:4096
    ds_read_b64_tr_b16 v[190:191], v211 offset:4096
    s_waitcnt lgkmcnt(8)
    v_mfma_f32_32x32x16_bf16 v[64:79], v[196:199], v[112:115], v[64:79]
    ds_read_b64_tr_b16 v[192:193], v212 offset:4096
    ds_read_b64_tr_b16 v[194:195], v213 offset:4096
    s_waitcnt lgkmcnt(8)
    v_mfma_f32_32x32x16_bf16 v[80:95], v[176:179], v[112:115], v[80:95]
    ds_read_b64_tr_b16 v[196:197], v214 offset:4096
    ds_read_b64_tr_b16 v[198:199], v215 offset:4096
    s_waitcnt lgkmcnt(8)
    v_mfma_f32_32x32x16_bf16 v[96:111], v[180:183], v[112:115], v[96:111]
    s_waitcnt vmcnt(6)
    s_barrier
    s_add_u32 m0, s26, 24576
    s_add_u32 s29, s27, 2883584
    buffer_load_dwordx4 v144, s[12:15], s29 offen offset:0 lds
    buffer_load_dwordx4 v145, s[12:15], s29 offen offset:1024 lds
    ds_read_b64_tr_b16 v[176:177], v208 offset:8192
    ds_read_b64_tr_b16 v[178:179], v209 offset:8192
    s_waitcnt lgkmcnt(8)
    v_mfma_f32_32x32x16_bf16 v[48:63], v[184:187], v[116:119], v[48:63]
    ds_read_b64_tr_b16 v[180:181], v210 offset:8192
    ds_read_b64_tr_b16 v[182:183], v211 offset:8192
    s_waitcnt lgkmcnt(8)
    v_mfma_f32_32x32x16_bf16 v[64:79], v[188:191], v[116:119], v[64:79]
    ds_read_b64_tr_b16 v[184:185], v212 offset:8192
    ds_read_b64_tr_b16 v[186:187], v213 offset:8192
    s_waitcnt lgkmcnt(8)
    v_mfma_f32_32x32x16_bf16 v[80:95], v[192:195], v[116:119], v[80:95]
    ds_read_b128 v[128:131], v150 offset:16384
    ds_read_b128 v[132:135], v151 offset:16384
    ds_read_b128 v[136:139], v152 offset:16384
    ds_read_b128 v[140:143], v153 offset:16384
    ds_read_b64_tr_b16 v[188:189], v214 offset:8192
    ds_read_b64_tr_b16 v[190:191], v215 offset:8192
    s_waitcnt lgkmcnt(12)
    v_mfma_f32_32x32x16_bf16 v[96:111], v[196:199], v[116:119], v[96:111]
    ds_read_b64_tr_b16 v[192:193], v208 offset:12288
    ds_read_b64_tr_b16 v[194:195], v209 offset:12288
    s_waitcnt lgkmcnt(12)
    v_mfma_f32_32x32x16_bf16 v[48:63], v[176:179], v[120:123], v[48:63]
    ds_read_b64_tr_b16 v[196:197], v210 offset:12288
    ds_read_b64_tr_b16 v[198:199], v211 offset:12288
    s_waitcnt lgkmcnt(12)
    v_mfma_f32_32x32x16_bf16 v[64:79], v[180:183], v[120:123], v[64:79]
    ds_read_b64_tr_b16 v[176:177], v212 offset:12288
    ds_read_b64_tr_b16 v[178:179], v213 offset:12288
    s_waitcnt lgkmcnt(12)
    v_mfma_f32_32x32x16_bf16 v[80:95], v[184:187], v[120:123], v[80:95]
    ds_read_b64_tr_b16 v[180:181], v214 offset:12288
    ds_read_b64_tr_b16 v[182:183], v215 offset:12288
    s_waitcnt lgkmcnt(8)
    v_mfma_f32_32x32x16_bf16 v[96:111], v[188:191], v[120:123], v[96:111]
    s_waitcnt vmcnt(6)
    s_barrier
    s_add_u32 m0, s26, 0
    s_add_u32 s29, s27, 3145728
    buffer_load_dwordx4 v144, s[12:15], s29 offen offset:0 lds
    buffer_load_dwordx4 v145, s[12:15], s29 offen offset:1024 lds
    ds_read_b64_tr_b16 v[184:185], v208 offset:16384
    ds_read_b64_tr_b16 v[186:187], v209 offset:16384
    s_waitcnt lgkmcnt(8)
    v_mfma_f32_32x32x16_bf16 v[48:63], v[192:195], v[124:127], v[48:63]
    ds_read_b64_tr_b16 v[188:189], v210 offset:16384
    ds_read_b64_tr_b16 v[190:191], v211 offset:16384
    s_waitcnt lgkmcnt(8)
    v_mfma_f32_32x32x16_bf16 v[64:79], v[196:199], v[124:127], v[64:79]
    ds_read_b64_tr_b16 v[192:193], v212 offset:16384
    ds_read_b64_tr_b16 v[194:195], v213 offset:16384
    s_waitcnt lgkmcnt(8)
    v_mfma_f32_32x32x16_bf16 v[80:95], v[176:179], v[124:127], v[80:95]
    ds_read_b64_tr_b16 v[196:197], v214 offset:16384
    ds_read_b64_tr_b16 v[198:199], v215 offset:16384
    s_waitcnt lgkmcnt(8)
    v_mfma_f32_32x32x16_bf16 v[96:111], v[180:183], v[124:127], v[96:111]
    s_add_u32 m0, s28, 16384
    s_add_u32 s29, s25, 896
    buffer_load_dwordx4 v146, s[4:7], s29 offen offset:0 lds
    buffer_load_dwordx4 v147, s[4:7], s29 offen offset:1024 lds
    buffer_load_dwordx4 v148, s[4:7], s29 offen offset:2048 lds
    buffer_load_dwordx4 v149, s[4:7], s29 offen offset:3072 lds
    ds_read_b64_tr_b16 v[176:177], v208 offset:20480
    ds_read_b64_tr_b16 v[178:179], v209 offset:20480
    s_waitcnt lgkmcnt(8)
    v_mfma_f32_32x32x16_bf16 v[48:63], v[184:187], v[128:131], v[48:63]
    ds_read_b64_tr_b16 v[180:181], v210 offset:20480
    ds_read_b64_tr_b16 v[182:183], v211 offset:20480
    s_waitcnt lgkmcnt(8)
    v_mfma_f32_32x32x16_bf16 v[64:79], v[188:191], v[128:131], v[64:79]
    ds_read_b64_tr_b16 v[184:185], v212 offset:20480
    ds_read_b64_tr_b16 v[186:187], v213 offset:20480
    s_waitcnt lgkmcnt(8)
    v_mfma_f32_32x32x16_bf16 v[80:95], v[192:195], v[128:131], v[80:95]
    ds_read_b64_tr_b16 v[188:189], v214 offset:20480
    ds_read_b64_tr_b16 v[190:191], v215 offset:20480
    s_waitcnt lgkmcnt(8)
    v_mfma_f32_32x32x16_bf16 v[96:111], v[196:199], v[128:131], v[96:111]
    s_waitcnt vmcnt(6)
    s_barrier
    s_add_u32 m0, s26, 8192
    s_add_u32 s29, s27, 3407872
    buffer_load_dwordx4 v144, s[12:15], s29 offen offset:0 lds
    buffer_load_dwordx4 v145, s[12:15], s29 offen offset:1024 lds
    ds_read_b64_tr_b16 v[192:193], v208 offset:24576
    ds_read_b64_tr_b16 v[194:195], v209 offset:24576
    s_waitcnt lgkmcnt(8)
    v_mfma_f32_32x32x16_bf16 v[48:63], v[176:179], v[132:135], v[48:63]
    ds_read_b64_tr_b16 v[196:197], v210 offset:24576
    ds_read_b64_tr_b16 v[198:199], v211 offset:24576
    s_waitcnt lgkmcnt(8)
    v_mfma_f32_32x32x16_bf16 v[64:79], v[180:183], v[132:135], v[64:79]
    ds_read_b64_tr_b16 v[176:177], v212 offset:24576
    ds_read_b64_tr_b16 v[178:179], v213 offset:24576
    s_waitcnt lgkmcnt(8)
    v_mfma_f32_32x32x16_bf16 v[80:95], v[184:187], v[132:135], v[80:95]
    ds_read_b128 v[112:115], v150 offset:0
    ds_read_b128 v[116:119], v151 offset:0
    ds_read_b128 v[120:123], v152 offset:0
    ds_read_b128 v[124:127], v153 offset:0
    ds_read_b64_tr_b16 v[180:181], v214 offset:24576
    ds_read_b64_tr_b16 v[182:183], v215 offset:24576
    s_waitcnt lgkmcnt(12)
    v_mfma_f32_32x32x16_bf16 v[96:111], v[188:191], v[132:135], v[96:111]
    ds_read_b64_tr_b16 v[184:185], v208 offset:28672
    ds_read_b64_tr_b16 v[186:187], v209 offset:28672
    s_waitcnt lgkmcnt(12)
    v_mfma_f32_32x32x16_bf16 v[48:63], v[192:195], v[136:139], v[48:63]
    ds_read_b64_tr_b16 v[188:189], v210 offset:28672
    ds_read_b64_tr_b16 v[190:191], v211 offset:28672
    s_waitcnt lgkmcnt(12)
    v_mfma_f32_32x32x16_bf16 v[64:79], v[196:199], v[136:139], v[64:79]
    ds_read_b64_tr_b16 v[192:193], v212 offset:28672
    ds_read_b64_tr_b16 v[194:195], v213 offset:28672
    s_waitcnt lgkmcnt(12)
    v_mfma_f32_32x32x16_bf16 v[80:95], v[176:179], v[136:139], v[80:95]
    ds_read_b64_tr_b16 v[196:197], v214 offset:28672
    ds_read_b64_tr_b16 v[198:199], v215 offset:28672
    s_waitcnt lgkmcnt(8)
    v_mfma_f32_32x32x16_bf16 v[96:111], v[180:183], v[136:139], v[96:111]
    s_waitcnt vmcnt(6)
    s_barrier
    s_add_u32 m0, s26, 16384
    s_add_u32 s29, s27, 3670016
    buffer_load_dwordx4 v144, s[12:15], s29 offen offset:0 lds
    buffer_load_dwordx4 v145, s[12:15], s29 offen offset:1024 lds
    ds_read_b64_tr_b16 v[176:177], v208 offset:0
    ds_read_b64_tr_b16 v[178:179], v209 offset:0
    s_waitcnt lgkmcnt(8)
    v_mfma_f32_32x32x16_bf16 v[48:63], v[184:187], v[140:143], v[48:63]
    ds_read_b64_tr_b16 v[180:181], v210 offset:0
    ds_read_b64_tr_b16 v[182:183], v211 offset:0
    s_waitcnt lgkmcnt(8)
    v_mfma_f32_32x32x16_bf16 v[64:79], v[188:191], v[140:143], v[64:79]
    ds_read_b64_tr_b16 v[184:185], v212 offset:0
    ds_read_b64_tr_b16 v[186:187], v213 offset:0
    s_waitcnt lgkmcnt(8)
    v_mfma_f32_32x32x16_bf16 v[80:95], v[192:195], v[140:143], v[80:95]
    ds_read_b64_tr_b16 v[188:189], v214 offset:0
    ds_read_b64_tr_b16 v[190:191], v215 offset:0
    s_waitcnt lgkmcnt(8)
    v_mfma_f32_32x32x16_bf16 v[96:111], v[196:199], v[140:143], v[96:111]
    s_add_u32 m0, s28, 0
    s_add_u32 s29, s25, 1024
    buffer_load_dwordx4 v146, s[4:7], s29 offen offset:0 lds
    buffer_load_dwordx4 v147, s[4:7], s29 offen offset:1024 lds
    buffer_load_dwordx4 v148, s[4:7], s29 offen offset:2048 lds
    buffer_load_dwordx4 v149, s[4:7], s29 offen offset:3072 lds
    ds_read_b64_tr_b16 v[192:193], v208 offset:4096
    ds_read_b64_tr_b16 v[194:195], v209 offset:4096
    s_waitcnt lgkmcnt(8)
    v_mfma_f32_32x32x16_bf16 v[48:63], v[176:179], v[112:115], v[48:63]
    ds_read_b64_tr_b16 v[196:197], v210 offset:4096
    ds_read_b64_tr_b16 v[198:199], v211 offset:4096
    s_waitcnt lgkmcnt(8)
    v_mfma_f32_32x32x16_bf16 v[64:79], v[180:183], v[112:115], v[64:79]
    ds_read_b64_tr_b16 v[176:177], v212 offset:4096
    ds_read_b64_tr_b16 v[178:179], v213 offset:4096
    s_waitcnt lgkmcnt(8)
    v_mfma_f32_32x32x16_bf16 v[80:95], v[184:187], v[112:115], v[80:95]
    ds_read_b64_tr_b16 v[180:181], v214 offset:4096
    ds_read_b64_tr_b16 v[182:183], v215 offset:4096
    s_waitcnt lgkmcnt(8)
    v_mfma_f32_32x32x16_bf16 v[96:111], v[188:191], v[112:115], v[96:111]
    s_waitcnt vmcnt(6)
    s_barrier
    s_add_u32 m0, s26, 24576
    s_add_u32 s29, s27, 3932160
    buffer_load_dwordx4 v144, s[12:15], s29 offen offset:0 lds
    buffer_load_dwordx4 v145, s[12:15], s29 offen offset:1024 lds
    ds_read_b64_tr_b16 v[184:185], v208 offset:8192
    ds_read_b64_tr_b16 v[186:187], v209 offset:8192
    s_waitcnt lgkmcnt(8)
    v_mfma_f32_32x32x16_bf16 v[48:63], v[192:195], v[116:119], v[48:63]
    ds_read_b64_tr_b16 v[188:189], v210 offset:8192
    ds_read_b64_tr_b16 v[190:191], v211 offset:8192
    s_waitcnt lgkmcnt(8)
    v_mfma_f32_32x32x16_bf16 v[64:79], v[196:199], v[116:119], v[64:79]
    ds_read_b64_tr_b16 v[192:193], v212 offset:8192
    ds_read_b64_tr_b16 v[194:195], v213 offset:8192
    s_waitcnt lgkmcnt(8)
    v_mfma_f32_32x32x16_bf16 v[80:95], v[176:179], v[116:119], v[80:95]
    ds_read_b128 v[128:131], v150 offset:16384
    ds_read_b128 v[132:135], v151 offset:16384
    ds_read_b128 v[136:139], v152 offset:16384
    ds_read_b128 v[140:143], v153 offset:16384
    ds_read_b64_tr_b16 v[196:197], v214 offset:8192
    ds_read_b64_tr_b16 v[198:199], v215 offset:8192
    s_waitcnt lgkmcnt(12)
    v_mfma_f32_32x32x16_bf16 v[96:111], v[180:183], v[116:119], v[96:111]
    ds_read_b64_tr_b16 v[176:177], v208 offset:12288
    ds_read_b64_tr_b16 v[178:179], v209 offset:12288
    s_waitcnt lgkmcnt(12)
    v_mfma_f32_32x32x16_bf16 v[48:63], v[184:187], v[120:123], v[48:63]
    ds_read_b64_tr_b16 v[180:181], v210 offset:12288
    ds_read_b64_tr_b16 v[182:183], v211 offset:12288
    s_waitcnt lgkmcnt(12)
    v_mfma_f32_32x32x16_bf16 v[64:79], v[188:191], v[120:123], v[64:79]
    ds_read_b64_tr_b16 v[184:185], v212 offset:12288
    ds_read_b64_tr_b16 v[186:187], v213 offset:12288
    s_waitcnt lgkmcnt(12)
    v_mfma_f32_32x32x16_bf16 v[80:95], v[192:195], v[120:123], v[80:95]
    ds_read_b64_tr_b16 v[188:189], v214 offset:12288
    ds_read_b64_tr_b16 v[190:191], v215 offset:12288
    s_waitcnt lgkmcnt(8)
    v_mfma_f32_32x32x16_bf16 v[96:111], v[196:199], v[120:123], v[96:111]
    s_waitcnt vmcnt(6)
    s_barrier
    s_add_u32 m0, s26, 0
    s_add_u32 s29, s27, 4194304
    buffer_load_dwordx4 v144, s[12:15], s29 offen offset:0 lds
    buffer_load_dwordx4 v145, s[12:15], s29 offen offset:1024 lds
    ds_read_b64_tr_b16 v[192:193], v208 offset:16384
    ds_read_b64_tr_b16 v[194:195], v209 offset:16384
    s_waitcnt lgkmcnt(8)
    v_mfma_f32_32x32x16_bf16 v[48:63], v[176:179], v[124:127], v[48:63]
    ds_read_b64_tr_b16 v[196:197], v210 offset:16384
    ds_read_b64_tr_b16 v[198:199], v211 offset:16384
    s_waitcnt lgkmcnt(8)
    v_mfma_f32_32x32x16_bf16 v[64:79], v[180:183], v[124:127], v[64:79]
    ds_read_b64_tr_b16 v[176:177], v212 offset:16384
    ds_read_b64_tr_b16 v[178:179], v213 offset:16384
    s_waitcnt lgkmcnt(8)
    v_mfma_f32_32x32x16_bf16 v[80:95], v[184:187], v[124:127], v[80:95]
    ds_read_b64_tr_b16 v[180:181], v214 offset:16384
    ds_read_b64_tr_b16 v[182:183], v215 offset:16384
    s_waitcnt lgkmcnt(8)
    v_mfma_f32_32x32x16_bf16 v[96:111], v[188:191], v[124:127], v[96:111]
    s_add_u32 m0, s28, 16384
    s_add_u32 s29, s25, 1152
    buffer_load_dwordx4 v146, s[4:7], s29 offen offset:0 lds
    buffer_load_dwordx4 v147, s[4:7], s29 offen offset:1024 lds
    buffer_load_dwordx4 v148, s[4:7], s29 offen offset:2048 lds
    buffer_load_dwordx4 v149, s[4:7], s29 offen offset:3072 lds
    ds_read_b64_tr_b16 v[184:185], v208 offset:20480
    ds_read_b64_tr_b16 v[186:187], v209 offset:20480
    s_waitcnt lgkmcnt(8)
    v_mfma_f32_32x32x16_bf16 v[48:63], v[192:195], v[128:131], v[48:63]
    ds_read_b64_tr_b16 v[188:189], v210 offset:20480
    ds_read_b64_tr_b16 v[190:191], v211 offset:20480
    s_waitcnt lgkmcnt(8)
    v_mfma_f32_32x32x16_bf16 v[64:79], v[196:199], v[128:131], v[64:79]
    ds_read_b64_tr_b16 v[192:193], v212 offset:20480
    ds_read_b64_tr_b16 v[194:195], v213 offset:20480
    s_waitcnt lgkmcnt(8)
    v_mfma_f32_32x32x16_bf16 v[80:95], v[176:179], v[128:131], v[80:95]
    ds_read_b64_tr_b16 v[196:197], v214 offset:20480
    ds_read_b64_tr_b16 v[198:199], v215 offset:20480
    s_waitcnt lgkmcnt(8)
    v_mfma_f32_32x32x16_bf16 v[96:111], v[180:183], v[128:131], v[96:111]
    s_waitcnt vmcnt(6)
    s_barrier
    s_add_u32 m0, s26, 8192
    s_add_u32 s29, s27, 4456448
    buffer_load_dwordx4 v144, s[12:15], s29 offen offset:0 lds
    buffer_load_dwordx4 v145, s[12:15], s29 offen offset:1024 lds
    ds_read_b64_tr_b16 v[176:177], v208 offset:24576
    ds_read_b64_tr_b16 v[178:179], v209 offset:24576
    s_waitcnt lgkmcnt(8)
    v_mfma_f32_32x32x16_bf16 v[48:63], v[184:187], v[132:135], v[48:63]
    ds_read_b64_tr_b16 v[180:181], v210 offset:24576
    ds_read_b64_tr_b16 v[182:183], v211 offset:24576
    s_waitcnt lgkmcnt(8)
    v_mfma_f32_32x32x16_bf16 v[64:79], v[188:191], v[132:135], v[64:79]
    ds_read_b64_tr_b16 v[184:185], v212 offset:24576
    ds_read_b64_tr_b16 v[186:187], v213 offset:24576
    s_waitcnt lgkmcnt(8)
    v_mfma_f32_32x32x16_bf16 v[80:95], v[192:195], v[132:135], v[80:95]
    ds_read_b128 v[112:115], v150 offset:0
    ds_read_b128 v[116:119], v151 offset:0
    ds_read_b128 v[120:123], v152 offset:0
    ds_read_b128 v[124:127], v153 offset:0
    ds_read_b64_tr_b16 v[188:189], v214 offset:24576
    ds_read_b64_tr_b16 v[190:191], v215 offset:24576
    s_waitcnt lgkmcnt(12)
    v_mfma_f32_32x32x16_bf16 v[96:111], v[196:199], v[132:135], v[96:111]
    ds_read_b64_tr_b16 v[192:193], v208 offset:28672
    ds_read_b64_tr_b16 v[194:195], v209 offset:28672
    s_waitcnt lgkmcnt(12)
    v_mfma_f32_32x32x16_bf16 v[48:63], v[176:179], v[136:139], v[48:63]
    ds_read_b64_tr_b16 v[196:197], v210 offset:28672
    ds_read_b64_tr_b16 v[198:199], v211 offset:28672
    s_waitcnt lgkmcnt(12)
    v_mfma_f32_32x32x16_bf16 v[64:79], v[180:183], v[136:139], v[64:79]
    ds_read_b64_tr_b16 v[176:177], v212 offset:28672
    ds_read_b64_tr_b16 v[178:179], v213 offset:28672
    s_waitcnt lgkmcnt(12)
    v_mfma_f32_32x32x16_bf16 v[80:95], v[184:187], v[136:139], v[80:95]
    ds_read_b64_tr_b16 v[180:181], v214 offset:28672
    ds_read_b64_tr_b16 v[182:183], v215 offset:28672
    s_waitcnt lgkmcnt(8)
    v_mfma_f32_32x32x16_bf16 v[96:111], v[188:191], v[136:139], v[96:111]
    s_waitcnt vmcnt(6)
    s_barrier
    s_add_u32 m0, s26, 16384
    s_add_u32 s29, s27, 4718592
    buffer_load_dwordx4 v144, s[12:15], s29 offen offset:0 lds
    buffer_load_dwordx4 v145, s[12:15], s29 offen offset:1024 lds
    ds_read_b64_tr_b16 v[184:185], v208 offset:0
    ds_read_b64_tr_b16 v[186:187], v209 offset:0
    s_waitcnt lgkmcnt(8)
    v_mfma_f32_32x32x16_bf16 v[48:63], v[192:195], v[140:143], v[48:63]
    ds_read_b64_tr_b16 v[188:189], v210 offset:0
    ds_read_b64_tr_b16 v[190:191], v211 offset:0
    s_waitcnt lgkmcnt(8)
    v_mfma_f32_32x32x16_bf16 v[64:79], v[196:199], v[140:143], v[64:79]
    ds_read_b64_tr_b16 v[192:193], v212 offset:0
    ds_read_b64_tr_b16 v[194:195], v213 offset:0
    s_waitcnt lgkmcnt(8)
    v_mfma_f32_32x32x16_bf16 v[80:95], v[176:179], v[140:143], v[80:95]
    ds_read_b64_tr_b16 v[196:197], v214 offset:0
    ds_read_b64_tr_b16 v[198:199], v215 offset:0
    s_waitcnt lgkmcnt(8)
    v_mfma_f32_32x32x16_bf16 v[96:111], v[180:183], v[140:143], v[96:111]
    ds_read_b64_tr_b16 v[176:177], v208 offset:4096
    ds_read_b64_tr_b16 v[178:179], v209 offset:4096
    s_waitcnt lgkmcnt(8)
    v_mfma_f32_32x32x16_bf16 v[48:63], v[184:187], v[112:115], v[48:63]
    ds_read_b64_tr_b16 v[180:181], v210 offset:4096
    ds_read_b64_tr_b16 v[182:183], v211 offset:4096
    s_waitcnt lgkmcnt(8)
    v_mfma_f32_32x32x16_bf16 v[64:79], v[188:191], v[112:115], v[64:79]
    ds_read_b64_tr_b16 v[184:185], v212 offset:4096
    ds_read_b64_tr_b16 v[186:187], v213 offset:4096
    s_waitcnt lgkmcnt(8)
    v_mfma_f32_32x32x16_bf16 v[80:95], v[192:195], v[112:115], v[80:95]
    ds_read_b64_tr_b16 v[188:189], v214 offset:4096
    ds_read_b64_tr_b16 v[190:191], v215 offset:4096
    s_waitcnt lgkmcnt(8)
    v_mfma_f32_32x32x16_bf16 v[96:111], v[196:199], v[112:115], v[96:111]
    s_waitcnt vmcnt(2)
    s_barrier
    s_add_u32 m0, s26, 24576
    s_add_u32 s29, s27, 4980736
    buffer_load_dwordx4 v144, s[12:15], s29 offen offset:0 lds
    buffer_load_dwordx4 v145, s[12:15], s29 offen offset:1024 lds
    s_add_u32 m0, s92, 32768
    s_add_u32 s29, s92, 16384
    buffer_load_dwordx4 v216, s[20:23], s29 offen offset:0 lds
    buffer_load_dwordx4 v217, s[20:23], s29 offen offset:1024 lds
    buffer_load_dwordx4 v218, s[20:23], s29 offen offset:2048 lds
    buffer_load_dwordx4 v219, s[20:23], s29 offen offset:3072 lds
    ds_read_b64_tr_b16 v[192:193], v208 offset:8192
    ds_read_b64_tr_b16 v[194:195], v209 offset:8192
    s_waitcnt lgkmcnt(8)
    v_mfma_f32_32x32x16_bf16 v[48:63], v[176:179], v[116:119], v[48:63]
    ds_read_b64_tr_b16 v[196:197], v210 offset:8192
    ds_read_b64_tr_b16 v[198:199], v211 offset:8192
    s_waitcnt lgkmcnt(8)
    v_mfma_f32_32x32x16_bf16 v[64:79], v[180:183], v[116:119], v[64:79]
    ds_read_b64_tr_b16 v[176:177], v212 offset:8192
    ds_read_b64_tr_b16 v[178:179], v213 offset:8192
    s_waitcnt lgkmcnt(8)
    v_mfma_f32_32x32x16_bf16 v[80:95], v[184:187], v[116:119], v[80:95]
    ds_read_b128 v[128:131], v150 offset:16384
    ds_read_b128 v[132:135], v151 offset:16384
    ds_read_b128 v[136:139], v152 offset:16384
    ds_read_b128 v[140:143], v153 offset:16384
    ds_read_b64_tr_b16 v[180:181], v214 offset:8192
    ds_read_b64_tr_b16 v[182:183], v215 offset:8192
    s_waitcnt lgkmcnt(12)
    v_mfma_f32_32x32x16_bf16 v[96:111], v[188:191], v[116:119], v[96:111]
    ds_read_b64_tr_b16 v[184:185], v208 offset:12288
    ds_read_b64_tr_b16 v[186:187], v209 offset:12288
    s_waitcnt lgkmcnt(12)
    v_mfma_f32_32x32x16_bf16 v[48:63], v[192:195], v[120:123], v[48:63]
    ds_read_b64_tr_b16 v[188:189], v210 offset:12288
    ds_read_b64_tr_b16 v[190:191], v211 offset:12288
    s_waitcnt lgkmcnt(12)
    v_mfma_f32_32x32x16_bf16 v[64:79], v[196:199], v[120:123], v[64:79]
    ds_read_b64_tr_b16 v[192:193], v212 offset:12288
    ds_read_b64_tr_b16 v[194:195], v213 offset:12288
    s_waitcnt lgkmcnt(12)
    v_mfma_f32_32x32x16_bf16 v[80:95], v[176:179], v[120:123], v[80:95]
    ds_read_b64_tr_b16 v[196:197], v214 offset:12288
    ds_read_b64_tr_b16 v[198:199], v215 offset:12288
    s_waitcnt lgkmcnt(8)
    v_mfma_f32_32x32x16_bf16 v[96:111], v[180:183], v[120:123], v[96:111]
    s_waitcnt vmcnt(6)
    s_barrier
    ds_read_b64_tr_b16 v[176:177], v208 offset:16384
    ds_read_b64_tr_b16 v[178:179], v209 offset:16384
    s_waitcnt lgkmcnt(8)
    v_mfma_f32_32x32x16_bf16 v[48:63], v[184:187], v[124:127], v[48:63]
    ds_read_b64_tr_b16 v[180:181], v210 offset:16384
    ds_read_b64_tr_b16 v[182:183], v211 offset:16384
    s_waitcnt lgkmcnt(8)
    v_mfma_f32_32x32x16_bf16 v[64:79], v[188:191], v[124:127], v[64:79]
    ds_read_b64_tr_b16 v[184:185], v212 offset:16384
    ds_read_b64_tr_b16 v[186:187], v213 offset:16384
    s_waitcnt lgkmcnt(8)
    v_mfma_f32_32x32x16_bf16 v[80:95], v[192:195], v[124:127], v[80:95]
    ds_read_b64_tr_b16 v[188:189], v214 offset:16384
    ds_read_b64_tr_b16 v[190:191], v215 offset:16384
    s_waitcnt lgkmcnt(8)
    v_mfma_f32_32x32x16_bf16 v[96:111], v[196:199], v[124:127], v[96:111]
    ds_read_b64_tr_b16 v[192:193], v208 offset:20480
    ds_read_b64_tr_b16 v[194:195], v209 offset:20480
    s_waitcnt lgkmcnt(8)
    v_mfma_f32_32x32x16_bf16 v[48:63], v[176:179], v[128:131], v[48:63]
    ds_read_b64_tr_b16 v[196:197], v210 offset:20480
    ds_read_b64_tr_b16 v[198:199], v211 offset:20480
    s_waitcnt lgkmcnt(8)
    v_mfma_f32_32x32x16_bf16 v[64:79], v[180:183], v[128:131], v[64:79]
    ds_read_b64_tr_b16 v[176:177], v212 offset:20480
    ds_read_b64_tr_b16 v[178:179], v213 offset:20480
    s_waitcnt lgkmcnt(8)
    v_mfma_f32_32x32x16_bf16 v[80:95], v[184:187], v[128:131], v[80:95]
    ds_read_b64_tr_b16 v[180:181], v214 offset:20480
    ds_read_b64_tr_b16 v[182:183], v215 offset:20480
    s_waitcnt lgkmcnt(8)
    v_mfma_f32_32x32x16_bf16 v[96:111], v[188:191], v[128:131], v[96:111]
    s_waitcnt vmcnt(4)
    s_barrier
    s_add_u32 m0, s92, 0
    s_add_u32 s29, s92, 0
    buffer_load_dwordx4 v216, s[96:99], s29 offen offset:0 lds
    buffer_load_dwordx4 v217, s[96:99], s29 offen offset:1024 lds
    buffer_load_dwordx4 v218, s[96:99], s29 offen offset:2048 lds
    buffer_load_dwordx4 v219, s[96:99], s29 offen offset:3072 lds
    s_add_u32 m0, s92, 49152
    s_add_u32 s29, s92, 32768
    buffer_load_dwordx4 v216, s[20:23], s29 offen offset:0 lds
    buffer_load_dwordx4 v217, s[20:23], s29 offen offset:1024 lds
    buffer_load_dwordx4 v218, s[20:23], s29 offen offset:2048 lds
    buffer_load_dwordx4 v219, s[20:23], s29 offen offset:3072 lds
    ds_read_b64_tr_b16 v[184:185], v208 offset:24576
    ds_read_b64_tr_b16 v[186:187], v209 offset:24576
    s_waitcnt lgkmcnt(8)
    v_mfma_f32_32x32x16_bf16 v[48:63], v[192:195], v[132:135], v[48:63]
    ds_read_b64_tr_b16 v[188:189], v210 offset:24576
    ds_read_b64_tr_b16 v[190:191], v211 offset:24576
    s_waitcnt lgkmcnt(8)
    v_mfma_f32_32x32x16_bf16 v[64:79], v[196:199], v[132:135], v[64:79]
    ds_read_b64_tr_b16 v[192:193], v212 offset:24576
    ds_read_b64_tr_b16 v[194:195], v213 offset:24576
    s_waitcnt lgkmcnt(8)
    v_mfma_f32_32x32x16_bf16 v[80:95], v[176:179], v[132:135], v[80:95]
    ds_read_b64_tr_b16 v[196:197], v214 offset:24576
    ds_read_b64_tr_b16 v[198:199], v215 offset:24576
    s_waitcnt lgkmcnt(8)
    v_mfma_f32_32x32x16_bf16 v[96:111], v[180:183], v[132:135], v[96:111]
    ds_read_b64_tr_b16 v[176:177], v208 offset:28672
    ds_read_b64_tr_b16 v[178:179], v209 offset:28672
    s_waitcnt lgkmcnt(8)
    v_mfma_f32_32x32x16_bf16 v[48:63], v[184:187], v[136:139], v[48:63]
    ds_read_b64_tr_b16 v[180:181], v210 offset:28672
    ds_read_b64_tr_b16 v[182:183], v211 offset:28672
    s_waitcnt lgkmcnt(8)
    v_mfma_f32_32x32x16_bf16 v[64:79], v[188:191], v[136:139], v[64:79]
    ds_read_b64_tr_b16 v[184:185], v212 offset:28672
    ds_read_b64_tr_b16 v[186:187], v213 offset:28672
    s_waitcnt lgkmcnt(8)
    v_mfma_f32_32x32x16_bf16 v[80:95], v[192:195], v[136:139], v[80:95]
    ds_read_b64_tr_b16 v[188:189], v214 offset:28672
    ds_read_b64_tr_b16 v[190:191], v215 offset:28672
    s_waitcnt lgkmcnt(8)
    v_mfma_f32_32x32x16_bf16 v[96:111], v[196:199], v[136:139], v[96:111]
    s_waitcnt lgkmcnt(6)
    v_mfma_f32_32x32x16_bf16 v[48:63], v[176:179], v[140:143], v[48:63]
    s_waitcnt lgkmcnt(4)
    v_mfma_f32_32x32x16_bf16 v[64:79], v[180:183], v[140:143], v[64:79]
    s_waitcnt lgkmcnt(2)
    v_mfma_f32_32x32x16_bf16 v[80:95], v[184:187], v[140:143], v[80:95]
    s_waitcnt lgkmcnt(0)
    v_mfma_f32_32x32x16_bf16 v[96:111], v[188:191], v[140:143], v[96:111]
    s_nop 5
    v_cvt_pk_bf16_f32 v16, v48, v49
    v_cvt_pk_bf16_f32 v17, v50, v51
    v_cvt_pk_bf16_f32 v18, v52, v53
    v_cvt_pk_bf16_f32 v19, v54, v55
    v_cvt_pk_bf16_f32 v20, v56, v57
    v_cvt_pk_bf16_f32 v21, v58, v59
    v_cvt_pk_bf16_f32 v22, v60, v61
    v_cvt_pk_bf16_f32 v23, v62, v63
    v_cvt_pk_bf16_f32 v24, v64, v65
    v_cvt_pk_bf16_f32 v25, v66, v67
    v_cvt_pk_bf16_f32 v26, v68, v69
    v_cvt_pk_bf16_f32 v27, v70, v71
    v_cvt_pk_bf16_f32 v28, v72, v73
    v_cvt_pk_bf16_f32 v29, v74, v75
    v_cvt_pk_bf16_f32 v30, v76, v77
    v_cvt_pk_bf16_f32 v31, v78, v79
    v_cvt_pk_bf16_f32 v32, v80, v81
    v_cvt_pk_bf16_f32 v33, v82, v83
    v_cvt_pk_bf16_f32 v34, v84, v85
    v_cvt_pk_bf16_f32 v35, v86, v87
    v_cvt_pk_bf16_f32 v36, v88, v89
    v_cvt_pk_bf16_f32 v37, v90, v91
    v_cvt_pk_bf16_f32 v38, v92, v93
    v_cvt_pk_bf16_f32 v39, v94, v95
    v_cvt_pk_bf16_f32 v40, v96, v97
    v_cvt_pk_bf16_f32 v41, v98, v99
    v_cvt_pk_bf16_f32 v42, v100, v101
    v_cvt_pk_bf16_f32 v43, v102, v103
    v_cvt_pk_bf16_f32 v44, v104, v105
    v_cvt_pk_bf16_f32 v45, v106, v107
    v_cvt_pk_bf16_f32 v46, v108, v109
    v_cvt_pk_bf16_f32 v47, v110, v111
    s_mov_b32 s30, 0x3e0293ee
    s_lshl_b32 s29, s38, 20
    s_add_u32 s4, s72, s29
    s_addc_u32 s5, s73, 0
    s_and_b32 s5, s5, 0xffff
    s_mov_b32 s6, 1048576
    s_mov_b32 s7, 0x00020000
    v_lshrrev_b32 v10, 1, v8
    v_lshl_or_b32 v10, v9, 1, v10
    v_and_b32 v11, 1, v8
    v_or_b32 v12, 0, v5
    v_xor_b32 v13, v10, v12
    v_lshlrev_b32 v13, 4, v13
    v_lshl_add_u32 v13, v11, 3, v13
    v_lshl_add_u32 v14, v12, 2, v7
    v_lshl_add_u32 v13, v14, 8, v13
    v_lshl_add_u32 v13, v7, 6, v13
    v_xor_b32 v208, 0, v13
    v_xor_b32 v210, 64, v13
    v_xor_b32 v212, 128, v13
    v_xor_b32 v214, 192, v13
    v_or_b32 v12, 2, v5
    v_xor_b32 v13, v10, v12
    v_lshlrev_b32 v13, 4, v13
    v_lshl_add_u32 v13, v11, 3, v13
    v_lshl_add_u32 v14, v12, 2, v7
    v_lshl_add_u32 v13, v14, 8, v13
    v_lshl_add_u32 v13, v7, 6, v13
    v_xor_b32 v209, 0, v13
    v_xor_b32 v211, 64, v13
    v_xor_b32 v213, 128, v13
    v_xor_b32 v215, 192, v13
    v_add_u32 v200, 16384, v200
    v_add_u32 v201, 16384, v201
    v_add_u32 v202, 16384, v202
    v_add_u32 v203, 16384, v203
    v_add_u32 v204, 16384, v204
    v_add_u32 v205, 16384, v205
    v_add_u32 v206, 16384, v206
    v_add_u32 v207, 16384, v207
    s_barrier
    ds_read_b128 v[176:179], v200 offset:49152
    ds_read_b128 v[180:183], v201 offset:49152
    ds_read_b128 v[184:187], v202 offset:49152
    ds_read_b128 v[188:191], v203 offset:49152
    ds_read_b128 v[192:195], v204 offset:49152
    ds_read_b128 v[196:199], v205 offset:49152
    s_waitcnt lgkmcnt(5)
    v_mfma_f32_32x32x16_bf16 v[112:127], v[176:179], v[16:19], 0
    ds_read_b128 v[176:179], v206 offset:49152
    s_waitcnt lgkmcnt(5)
    v_mfma_f32_32x32x16_bf16 v[112:127], v[180:183], v[20:23], v[112:127]
    ds_read_b128 v[180:183], v207 offset:49152
    s_waitcnt lgkmcnt(5)
    v_mfma_f32_32x32x16_bf16 v[112:127], v[184:187], v[24:27], v[112:127]
    ds_read_b128 v[184:187], v200 offset:57344
    s_waitcnt lgkmcnt(5)
    v_mfma_f32_32x32x16_bf16 v[112:127], v[188:191], v[28:31], v[112:127]
    ds_read_b128 v[188:191], v201 offset:57344
    s_waitcnt lgkmcnt(5)
    v_mfma_f32_32x32x16_bf16 v[112:127], v[192:195], v[32:35], v[112:127]
    ds_read_b128 v[192:195], v202 offset:57344
    s_waitcnt lgkmcnt(5)
    v_mfma_f32_32x32x16_bf16 v[112:127], v[196:199], v[36:39], v[112:127]
    ds_read_b128 v[196:199], v203 offset:57344
    s_waitcnt lgkmcnt(5)
    v_mfma_f32_32x32x16_bf16 v[112:127], v[176:179], v[40:43], v[112:127]
    ds_read_b128 v[176:179], v204 offset:57344
    s_waitcnt lgkmcnt(5)
    v_mfma_f32_32x32x16_bf16 v[112:127], v[180:183], v[44:47], v[112:127]
    ds_read_b128 v[180:183], v205 offset:57344
    s_waitcnt lgkmcnt(5)
    v_mfma_f32_32x32x16_bf16 v[128:143], v[184:187], v[16:19], 0
    ds_read_b128 v[184:187], v206 offset:57344
    s_waitcnt lgkmcnt(5)
    v_mfma_f32_32x32x16_bf16 v[128:143], v[188:191], v[20:23], v[128:143]
    ds_read_b128 v[188:191], v207 offset:57344
    s_waitcnt lgkmcnt(5)
    v_mfma_f32_32x32x16_bf16 v[128:143], v[192:195], v[24:27], v[128:143]
    s_waitcnt lgkmcnt(4)
    v_mfma_f32_32x32x16_bf16 v[128:143], v[196:199], v[28:31], v[128:143]
    s_waitcnt lgkmcnt(3)
    v_mfma_f32_32x32x16_bf16 v[128:143], v[176:179], v[32:35], v[128:143]
    s_waitcnt lgkmcnt(2)
    v_mfma_f32_32x32x16_bf16 v[128:143], v[180:183], v[36:39], v[128:143]
    s_waitcnt lgkmcnt(1)
    v_mfma_f32_32x32x16_bf16 v[128:143], v[184:187], v[40:43], v[128:143]
    s_waitcnt lgkmcnt(0)
    v_mfma_f32_32x32x16_bf16 v[128:143], v[188:191], v[44:47], v[128:143]
    v_max3_f32 v225, v112, v113, v114
    s_nop 10
    v_max3_f32 v226, v128, v129, v130
    v_max3_f32 v225, v225, v115, v116
    v_max3_f32 v226, v226, v131, v132
    v_max3_f32 v225, v225, v117, v118
    v_max3_f32 v226, v226, v133, v134
    v_max3_f32 v225, v225, v119, v120
    v_max3_f32 v226, v226, v135, v136
    v_max3_f32 v225, v225, v121, v122
    v_max3_f32 v226, v226, v137, v138
    v_max3_f32 v225, v225, v123, v124
    v_max3_f32 v226, v226, v139, v140
    v_max3_f32 v225, v225, v125, v126
    v_max3_f32 v226, v226, v141, v142
    v_max3_f32 v225, v225, v226, v127
    v_max_f32 v225, v225, v143
    v_mov_b32 v226, v225
    s_nop 1
    v_permlane32_swap_b32 v225, v226
    v_max_f32 v220, v225, v226
    v_mul_f32 v224, s30, v220
    v_fma_f32 v112, v112, s30, -v224
    v_fma_f32 v113, v113, s30, -v224
    v_fma_f32 v114, v114, s30, -v224
    v_fma_f32 v115, v115, s30, -v224
    v_fma_f32 v116, v116, s30, -v224
    v_fma_f32 v117, v117, s30, -v224
    v_fma_f32 v118, v118, s30, -v224
    v_fma_f32 v119, v119, s30, -v224
    v_fma_f32 v120, v120, s30, -v224
    v_fma_f32 v121, v121, s30, -v224
    v_fma_f32 v122, v122, s30, -v224
    v_fma_f32 v123, v123, s30, -v224
    v_fma_f32 v124, v124, s30, -v224
    v_fma_f32 v125, v125, s30, -v224
    v_fma_f32 v126, v126, s30, -v224
    v_fma_f32 v127, v127, s30, -v224
    v_fma_f32 v128, v128, s30, -v224
    v_fma_f32 v129, v129, s30, -v224
    v_fma_f32 v130, v130, s30, -v224
    v_fma_f32 v131, v131, s30, -v224
    v_fma_f32 v132, v132, s30, -v224
    v_fma_f32 v133, v133, s30, -v224
    v_fma_f32 v134, v134, s30, -v224
    v_fma_f32 v135, v135, s30, -v224
    v_fma_f32 v136, v136, s30, -v224
    v_fma_f32 v137, v137, s30, -v224
    v_fma_f32 v138, v138, s30, -v224
    v_fma_f32 v139, v139, s30, -v224
    v_fma_f32 v140, v140, s30, -v224
    v_fma_f32 v141, v141, s30, -v224
    v_fma_f32 v142, v142, s30, -v224
    v_fma_f32 v143, v143, s30, -v224
    s_waitcnt vmcnt(8)
    s_barrier
    s_add_u32 m0, s92, 16384
    s_add_u32 s29, s92, 16384
    buffer_load_dwordx4 v216, s[96:99], s29 offen offset:0 lds
    buffer_load_dwordx4 v217, s[96:99], s29 offen offset:1024 lds
    buffer_load_dwordx4 v218, s[96:99], s29 offen offset:2048 lds
    buffer_load_dwordx4 v219, s[96:99], s29 offen offset:3072 lds
    ds_read_b128 v[176:179], v200 offset:16384
    ds_read_b128 v[180:183], v201 offset:16384
    ds_read_b128 v[184:187], v202 offset:16384
    ds_read_b128 v[188:191], v203 offset:16384
    ds_read_b128 v[192:195], v204 offset:16384
    v_exp_f32 v112, v112
    v_exp_f32 v113, v113
    v_exp_f32 v114, v114
    v_exp_f32 v115, v115
    v_exp_f32 v116, v116
    v_exp_f32 v117, v117
    v_exp_f32 v118, v118
    v_exp_f32 v119, v119
    ds_read_b128 v[196:199], v205 offset:16384
    s_waitcnt lgkmcnt(5)
    v_mfma_f32_32x32x16_bf16 v[144:159], v[176:179], v[16:19], 0
    v_exp_f32 v120, v120
    v_exp_f32 v121, v121
    v_exp_f32 v122, v122
    v_exp_f32 v123, v123
    v_exp_f32 v124, v124
    ds_read_b128 v[176:179], v206 offset:16384
    s_waitcnt lgkmcnt(5)
    v_mfma_f32_32x32x16_bf16 v[144:159], v[180:183], v[20:23], v[144:159]
    v_exp_f32 v125, v125
    v_exp_f32 v126, v126
    v_exp_f32 v127, v127
    v_exp_f32 v128, v128
    v_exp_f32 v129, v129
    ds_read_b128 v[180:183], v207 offset:16384
    s_waitcnt lgkmcnt(5)
    v_mfma_f32_32x32x16_bf16 v[144:159], v[184:187], v[24:27], v[144:159]
    v_exp_f32 v130, v130
    v_exp_f32 v131, v131
    v_exp_f32 v132, v132
    v_exp_f32 v133, v133
    v_exp_f32 v134, v134
    ds_read_b128 v[184:187], v200 offset:24576
    s_waitcnt lgkmcnt(5)
    v_mfma_f32_32x32x16_bf16 v[144:159], v[188:191], v[28:31], v[144:159]
    v_exp_f32 v135, v135
    v_exp_f32 v136, v136
    v_exp_f32 v137, v137
    v_exp_f32 v138, v138
    v_exp_f32 v139, v139
    ds_read_b128 v[188:191], v201 offset:24576
    s_waitcnt lgkmcnt(5)
    v_mfma_f32_32x32x16_bf16 v[144:159], v[192:195], v[32:35], v[144:159]
    v_exp_f32 v140, v140
    v_exp_f32 v141, v141
    v_exp_f32 v142, v142
    v_exp_f32 v143, v143
    v_add_f32 v225, v112, v113
    ds_read_b128 v[192:195], v202 offset:24576
    s_waitcnt lgkmcnt(5)
    v_mfma_f32_32x32x16_bf16 v[144:159], v[196:199], v[36:39], v[144:159]
    v_add_f32 v226, v120, v121
    v_add_f32 v227, v128, v129
    v_add_f32 v228, v136, v137
    v_add_f32 v225, v225, v114
    v_add_f32 v226, v226, v122
    ds_read_b128 v[196:199], v203 offset:24576
    s_waitcnt lgkmcnt(5)
    v_mfma_f32_32x32x16_bf16 v[144:159], v[176:179], v[40:43], v[144:159]
    v_add_f32 v227, v227, v130
    v_add_f32 v228, v228, v138
    v_add_f32 v225, v225, v115
    v_add_f32 v226, v226, v123
    v_add_f32 v227, v227, v131
    ds_read_b128 v[176:179], v204 offset:24576
    s_waitcnt lgkmcnt(5)
    v_mfma_f32_32x32x16_bf16 v[144:159], v[180:183], v[44:47], v[144:159]
    v_add_f32 v228, v228, v139
    v_add_f32 v225, v225, v116
    v_add_f32 v226, v226, v124
    v_add_f32 v227, v227, v132
    ds_read_b128 v[180:183], v205 offset:24576
    s_waitcnt lgkmcnt(5)
    v_mfma_f32_32x32x16_bf16 v[160:175], v[184:187], v[16:19], 0
    v_add_f32 v228, v228, v140
    v_add_f32 v225, v225, v117
    v_add_f32 v226, v226, v125
    v_add_f32 v227, v227, v133
    ds_read_b128 v[184:187], v206 offset:24576
    s_waitcnt lgkmcnt(5)
    v_mfma_f32_32x32x16_bf16 v[160:175], v[188:191], v[20:23], v[160:175]
    v_add_f32 v228, v228, v141
    v_add_f32 v225, v225, v118
    v_add_f32 v226, v226, v126
    v_add_f32 v227, v227, v134
    ds_read_b128 v[188:191], v207 offset:24576
    s_waitcnt lgkmcnt(5)
    v_mfma_f32_32x32x16_bf16 v[160:175], v[192:195], v[24:27], v[160:175]
    v_add_f32 v228, v228, v142
    v_add_f32 v225, v225, v119
    v_add_f32 v226, v226, v127
    v_add_f32 v227, v227, v135
    s_waitcnt lgkmcnt(4)
    v_mfma_f32_32x32x16_bf16 v[160:175], v[196:199], v[28:31], v[160:175]
    v_add_f32 v228, v228, v143
    v_add_f32 v225, v225, v226
    v_add_f32 v227, v227, v228
    v_add_f32 v221, v225, v227
    s_waitcnt lgkmcnt(3)
    v_mfma_f32_32x32x16_bf16 v[160:175], v[176:179], v[32:35], v[160:175]
    v_cvt_pk_bf16_f32 v112, v112, v113
    v_cvt_pk_bf16_f32 v113, v114, v115
    v_cvt_pk_bf16_f32 v114, v116, v117
    v_cvt_pk_bf16_f32 v115, v118, v119
    s_waitcnt lgkmcnt(2)
    v_mfma_f32_32x32x16_bf16 v[160:175], v[180:183], v[36:39], v[160:175]
    v_cvt_pk_bf16_f32 v116, v120, v121
    v_cvt_pk_bf16_f32 v117, v122, v123
    v_cvt_pk_bf16_f32 v118, v124, v125
    v_cvt_pk_bf16_f32 v119, v126, v127
    s_waitcnt lgkmcnt(1)
    v_mfma_f32_32x32x16_bf16 v[160:175], v[184:187], v[40:43], v[160:175]
    v_cvt_pk_bf16_f32 v120, v128, v129
    v_cvt_pk_bf16_f32 v121, v130, v131
    v_cvt_pk_bf16_f32 v122, v132, v133
    v_cvt_pk_bf16_f32 v123, v134, v135
    s_waitcnt lgkmcnt(0)
    v_mfma_f32_32x32x16_bf16 v[160:175], v[188:191], v[44:47], v[160:175]
    v_cvt_pk_bf16_f32 v124, v136, v137
    v_cvt_pk_bf16_f32 v125, v138, v139
    v_cvt_pk_bf16_f32 v126, v140, v141
    v_cvt_pk_bf16_f32 v127, v142, v143
    s_waitcnt vmcnt(8)
    s_barrier
    s_add_u32 m0, s92, 65536
    s_add_u32 s29, s92, 49152
    buffer_load_dwordx4 v216, s[20:23], s29 offen offset:0 lds
    buffer_load_dwordx4 v217, s[20:23], s29 offen offset:1024 lds
    buffer_load_dwordx4 v218, s[20:23], s29 offen offset:2048 lds
    buffer_load_dwordx4 v219, s[20:23], s29 offen offset:3072 lds
    ds_read_b64_tr_b16 v[176:177], v208 offset:0
    ds_read_b64_tr_b16 v[178:179], v209 offset:0
    ds_read_b64_tr_b16 v[180:181], v210 offset:0
    ds_read_b64_tr_b16 v[182:183], v211 offset:0
    ds_read_b64_tr_b16 v[184:185], v212 offset:0
    ds_read_b64_tr_b16 v[186:187], v213 offset:0
    ds_read_b64_tr_b16 v[188:189], v214 offset:0
    ds_read_b64_tr_b16 v[190:191], v215 offset:0
    v_max3_f32 v225, v144, v145, v146
    v_max3_f32 v226, v160, v161, v162
    v_max3_f32 v225, v225, v147, v148
    v_max3_f32 v226, v226, v163, v164
    v_max3_f32 v225, v225, v149, v150
    v_max3_f32 v226, v226, v165, v166
    ds_read_b64_tr_b16 v[192:193], v208 offset:4096
    ds_read_b64_tr_b16 v[194:195], v209 offset:4096
    s_waitcnt lgkmcnt(8)
    v_mfma_f32_32x32x16_bf16 v[48:63], v[176:179], v[112:115], 0
    v_max3_f32 v225, v225, v151, v152
    v_max3_f32 v226, v226, v167, v168
    v_max3_f32 v225, v225, v153, v154
    v_max3_f32 v226, v226, v169, v170
    ds_read_b64_tr_b16 v[196:197], v210 offset:4096
    ds_read_b64_tr_b16 v[198:199], v211 offset:4096
    s_waitcnt lgkmcnt(8)
    v_mfma_f32_32x32x16_bf16 v[64:79], v[180:183], v[112:115], 0
    v_max3_f32 v225, v225, v155, v156
    v_max3_f32 v226, v226, v171, v172
    v_max3_f32 v225, v225, v157, v158
    v_max3_f32 v226, v226, v173, v174
    ds_read_b64_tr_b16 v[176:177], v212 offset:4096
    ds_read_b64_tr_b16 v[178:179], v213 offset:4096
    s_waitcnt lgkmcnt(8)
    v_mfma_f32_32x32x16_bf16 v[80:95], v[184:187], v[112:115], 0
    v_max3_f32 v225, v225, v226, v159
    v_max_f32 v225, v225, v175
    v_mov_b32 v226, v225
    ds_read_b64_tr_b16 v[180:181], v214 offset:4096
    ds_read_b64_tr_b16 v[182:183], v215 offset:4096
    s_waitcnt lgkmcnt(8)
    v_mfma_f32_32x32x16_bf16 v[96:111], v[188:191], v[112:115], 0
    v_permlane32_swap_b32 v225, v226
    v_max3_f32 v227, v225, v226, v220
    v_sub_f32 v228, v220, v227
    ds_read_b64_tr_b16 v[184:185], v208 offset:8192
    ds_read_b64_tr_b16 v[186:187], v209 offset:8192
    s_waitcnt lgkmcnt(8)
    v_mfma_f32_32x32x16_bf16 v[48:63], v[192:195], v[116:119], v[48:63]
    v_mul_f32 v228, s30, v228
    v_exp_f32 v222, v228
    v_mov_b32 v220, v227
    ds_read_b64_tr_b16 v[188:189], v210 offset:8192
    ds_read_b64_tr_b16 v[190:191], v211 offset:8192
    s_waitcnt lgkmcnt(8)
    v_mfma_f32_32x32x16_bf16 v[64:79], v[196:199], v[116:119], v[64:79]
    v_mul_f32 v224, s30, v220
    v_fma_f32 v144, v144, s30, -v224
    v_fma_f32 v145, v145, s30, -v224
    ds_read_b64_tr_b16 v[192:193], v212 offset:8192
    ds_read_b64_tr_b16 v[194:195], v213 offset:8192
    s_waitcnt lgkmcnt(8)
    v_mfma_f32_32x32x16_bf16 v[80:95], v[176:179], v[116:119], v[80:95]
    v_fma_f32 v146, v146, s30, -v224
    v_fma_f32 v147, v147, s30, -v224
    v_fma_f32 v148, v148, s30, -v224
    ds_read_b64_tr_b16 v[196:197], v214 offset:8192
    ds_read_b64_tr_b16 v[198:199], v215 offset:8192
    s_waitcnt lgkmcnt(8)
    v_mfma_f32_32x32x16_bf16 v[96:111], v[180:183], v[116:119], v[96:111]
    v_fma_f32 v149, v149, s30, -v224
    v_fma_f32 v150, v150, s30, -v224
    v_fma_f32 v151, v151, s30, -v224
    ds_read_b64_tr_b16 v[176:177], v208 offset:12288
    ds_read_b64_tr_b16 v[178:179], v209 offset:12288
    s_waitcnt lgkmcnt(8)
    v_mfma_f32_32x32x16_bf16 v[48:63], v[184:187], v[120:123], v[48:63]
    v_fma_f32 v152, v152, s30, -v224
    v_fma_f32 v153, v153, s30, -v224
    v_fma_f32 v154, v154, s30, -v224
    ds_read_b64_tr_b16 v[180:181], v210 offset:12288
    ds_read_b64_tr_b16 v[182:183], v211 offset:12288
    s_waitcnt lgkmcnt(8)
    v_mfma_f32_32x32x16_bf16 v[64:79], v[188:191], v[120:123], v[64:79]
    v_fma_f32 v155, v155, s30, -v224
    v_fma_f32 v156, v156, s30, -v224
    v_fma_f32 v157, v157, s30, -v224
    ds_read_b64_tr_b16 v[184:185], v212 offset:12288
    ds_read_b64_tr_b16 v[186:187], v213 offset:12288
    s_waitcnt lgkmcnt(8)
    v_mfma_f32_32x32x16_bf16 v[80:95], v[192:195], v[120:123], v[80:95]
    v_fma_f32 v158, v158, s30, -v224
    v_fma_f32 v159, v159, s30, -v224
    v_fma_f32 v160, v160, s30, -v224
    ds_read_b64_tr_b16 v[188:189], v214 offset:12288
    ds_read_b64_tr_b16 v[190:191], v215 offset:12288
    s_waitcnt lgkmcnt(8)
    v_mfma_f32_32x32x16_bf16 v[96:111], v[196:199], v[120:123], v[96:111]
    v_fma_f32 v161, v161, s30, -v224
    v_fma_f32 v162, v162, s30, -v224
    v_fma_f32 v163, v163, s30, -v224
    s_waitcnt lgkmcnt(6)
    v_mfma_f32_32x32x16_bf16 v[48:63], v[176:179], v[124:127], v[48:63]
    v_fma_f32 v164, v164, s30, -v224
    v_fma_f32 v165, v165, s30, -v224
    v_fma_f32 v166, v166, s30, -v224
    s_waitcnt lgkmcnt(4)
    v_mfma_f32_32x32x16_bf16 v[64:79], v[180:183], v[124:127], v[64:79]
    v_fma_f32 v167, v167, s30, -v224
    v_fma_f32 v168, v168, s30, -v224
    v_fma_f32 v169, v169, s30, -v224
    s_waitcnt lgkmcnt(2)
    v_mfma_f32_32x32x16_bf16 v[80:95], v[184:187], v[124:127], v[80:95]
    v_fma_f32 v170, v170, s30, -v224
    v_fma_f32 v171, v171, s30, -v224
    v_fma_f32 v172, v172, s30, -v224
    s_waitcnt lgkmcnt(0)
    v_mfma_f32_32x32x16_bf16 v[96:111], v[188:191], v[124:127], v[96:111]
    v_fma_f32 v173, v173, s30, -v224
    v_fma_f32 v174, v174, s30, -v224
    v_fma_f32 v175, v175, s30, -v224
    s_waitcnt vmcnt(8)
    s_barrier
    s_add_u32 m0, s92, 32768
    s_add_u32 s29, s92, 32768
    buffer_load_dwordx4 v216, s[96:99], s29 offen offset:0 lds
    buffer_load_dwordx4 v217, s[96:99], s29 offen offset:1024 lds
    buffer_load_dwordx4 v218, s[96:99], s29 offen offset:2048 lds
    buffer_load_dwordx4 v219, s[96:99], s29 offen offset:3072 lds
    ds_read_b128 v[176:179], v200 offset:32768
    ds_read_b128 v[180:183], v201 offset:32768
    ds_read_b128 v[184:187], v202 offset:32768
    ds_read_b128 v[188:191], v203 offset:32768
    ds_read_b128 v[192:195], v204 offset:32768
    v_exp_f32 v144, v144
    v_pk_mul_f32 v[48:49], v[48:49], v[222:223] op_sel_hi:[1,0]
    v_exp_f32 v145, v145
    v_pk_mul_f32 v[50:51], v[50:51], v[222:223] op_sel_hi:[1,0]
    v_exp_f32 v146, v146
    v_pk_mul_f32 v[52:53], v[52:53], v[222:223] op_sel_hi:[1,0]
    v_exp_f32 v147, v147
    v_pk_mul_f32 v[54:55], v[54:55], v[222:223] op_sel_hi:[1,0]
    ds_read_b128 v[196:199], v205 offset:32768
    s_waitcnt lgkmcnt(5)
    v_mfma_f32_32x32x16_bf16 v[112:127], v[176:179], v[16:19], 0
    v_exp_f32 v148, v148
    v_pk_mul_f32 v[56:57], v[56:57], v[222:223] op_sel_hi:[1,0]
    v_exp_f32 v149, v149
    v_pk_mul_f32 v[58:59], v[58:59], v[222:223] op_sel_hi:[1,0]
    v_exp_f32 v150, v150
    v_pk_mul_f32 v[60:61], v[60:61], v[222:223] op_sel_hi:[1,0]
    v_exp_f32 v151, v151
    ds_read_b128 v[176:179], v206 offset:32768
    s_waitcnt lgkmcnt(5)
    v_mfma_f32_32x32x16_bf16 v[112:127], v[180:183], v[20:23], v[112:127]
    v_pk_mul_f32 v[62:63], v[62:63], v[222:223] op_sel_hi:[1,0]
    v_exp_f32 v152, v152
    v_pk_mul_f32 v[64:65], v[64:65], v[222:223] op_sel_hi:[1,0]
    v_exp_f32 v153, v153
    v_pk_mul_f32 v[66:67], v[66:67], v[222:223] op_sel_hi:[1,0]
    v_exp_f32 v154, v154
    v_pk_mul_f32 v[68:69], v[68:69], v[222:223] op_sel_hi:[1,0]
    ds_read_b128 v[180:183], v207 offset:32768
    s_waitcnt lgkmcnt(5)
    v_mfma_f32_32x32x16_bf16 v[112:127], v[184:187], v[24:27], v[112:127]
    v_exp_f32 v155, v155
    v_pk_mul_f32 v[70:71], v[70:71], v[222:223] op_sel_hi:[1,0]
    v_exp_f32 v156, v156
    v_pk_mul_f32 v[72:73], v[72:73], v[222:223] op_sel_hi:[1,0]
    v_exp_f32 v157, v157
    v_pk_mul_f32 v[74:75], v[74:75], v[222:223] op_sel_hi:[1,0]
    v_exp_f32 v158, v158
    ds_read_b128 v[184:187], v200 offset:40960
    s_waitcnt lgkmcnt(5)
    v_mfma_f32_32x32x16_bf16 v[112:127], v[188:191], v[28:31], v[112:127]
    v_pk_mul_f32 v[76:77], v[76:77], v[222:223] op_sel_hi:[1,0]
    v_exp_f32 v159, v159
    v_pk_mul_f32 v[78:79], v[78:79], v[222:223] op_sel_hi:[1,0]
    v_exp_f32 v160, v160
    v_pk_mul_f32 v[80:81], v[80:81], v[222:223] op_sel_hi:[1,0]
    v_exp_f32 v161, v161
    v_pk_mul_f32 v[82:83], v[82:83], v[222:223] op_sel_hi:[1,0]
    ds_read_b128 v[188:191], v201 offset:40960
    s_waitcnt lgkmcnt(5)
    v_mfma_f32_32x32x16_bf16 v[112:127], v[192:195], v[32:35], v[112:127]
    v_exp_f32 v162, v162
    v_pk_mul_f32 v[84:85], v[84:85], v[222:223] op_sel_hi:[1,0]
    v_exp_f32 v163, v163
    v_pk_mul_f32 v[86:87], v[86:87], v[222:223] op_sel_hi:[1,0]
    v_exp_f32 v164, v164
    v_pk_mul_f32 v[88:89], v[88:89], v[222:223] op_sel_hi:[1,0]
    v_exp_f32 v165, v165
    ds_read_b128 v[192:195], v202 offset:40960
    s_waitcnt lgkmcnt(5)
    v_mfma_f32_32x32x16_bf16 v[112:127], v[196:199], v[36:39], v[112:127]
    v_pk_mul_f32 v[90:91], v[90:91], v[222:223] op_sel_hi:[1,0]
    v_exp_f32 v166, v166
    v_pk_mul_f32 v[92:93], v[92:93], v[222:223] op_sel_hi:[1,0]
    v_exp_f32 v167, v167
    v_pk_mul_f32 v[94:95], v[94:95], v[222:223] op_sel_hi:[1,0]
    v_exp_f32 v168, v168
    v_pk_mul_f32 v[96:97], v[96:97], v[222:223] op_sel_hi:[1,0]
    ds_read_b128 v[196:199], v203 offset:40960
    s_waitcnt lgkmcnt(5)
    v_mfma_f32_32x32x16_bf16 v[112:127], v[176:179], v[40:43], v[112:127]
    v_exp_f32 v169, v169
    v_pk_mul_f32 v[98:99], v[98:99], v[222:223] op_sel_hi:[1,0]
    v_exp_f32 v170, v170
    v_pk_mul_f32 v[100:101], v[100:101], v[222:223] op_sel_hi:[1,0]
    v_exp_f32 v171, v171
    v_pk_mul_f32 v[102:103], v[102:103], v[222:223] op_sel_hi:[1,0]
    v_exp_f32 v172, v172
    ds_read_b128 v[176:179], v204 offset:40960
    s_waitcnt lgkmcnt(5)
    v_mfma_f32_32x32x16_bf16 v[112:127], v[180:183], v[44:47], v[112:127]
    v_pk_mul_f32 v[104:105], v[104:105], v[222:223] op_sel_hi:[1,0]
    v_exp_f32 v173, v173
    v_pk_mul_f32 v[106:107], v[106:107], v[222:223] op_sel_hi:[1,0]
    v_exp_f32 v174, v174
    v_pk_mul_f32 v[108:109], v[108:109], v[222:223] op_sel_hi:[1,0]
    v_exp_f32 v175, v175
    v_pk_mul_f32 v[110:111], v[110:111], v[222:223] op_sel_hi:[1,0]
    ds_read_b128 v[180:183], v205 offset:40960
    s_waitcnt lgkmcnt(5)
    v_mfma_f32_32x32x16_bf16 v[128:143], v[184:187], v[16:19], 0
    v_add_f32 v225, v144, v145
    v_add_f32 v226, v152, v153
    v_add_f32 v227, v160, v161
    v_add_f32 v228, v168, v169
    v_add_f32 v225, v225, v146
    v_add_f32 v226, v226, v154
    ds_read_b128 v[184:187], v206 offset:40960
    s_waitcnt lgkmcnt(5)
    v_mfma_f32_32x32x16_bf16 v[128:143], v[188:191], v[20:23], v[128:143]
    v_add_f32 v227, v227, v162
    v_add_f32 v228, v228, v170
    v_add_f32 v225, v225, v147
    v_add_f32 v226, v226, v155
    v_add_f32 v227, v227, v163
    v_add_f32 v228, v228, v171
    ds_read_b128 v[188:191], v207 offset:40960
    s_waitcnt lgkmcnt(5)
    v_mfma_f32_32x32x16_bf16 v[128:143], v[192:195], v[24:27], v[128:143]
    v_add_f32 v225, v225, v148
    v_add_f32 v226, v226, v156
    v_add_f32 v227, v227, v164
    v_add_f32 v228, v228, v172
    v_add_f32 v225, v225, v149
    v_add_f32 v226, v226, v157
    s_waitcnt lgkmcnt(4)
    v_mfma_f32_32x32x16_bf16 v[128:143], v[196:199], v[28:31], v[128:143]
    v_add_f32 v227, v227, v165
    v_add_f32 v228, v228, v173
    v_add_f32 v225, v225, v150
    v_add_f32 v226, v226, v158
    v_add_f32 v227, v227, v166
    v_add_f32 v228, v228, v174
    s_waitcnt lgkmcnt(3)
    v_mfma_f32_32x32x16_bf16 v[128:143], v[176:179], v[32:35], v[128:143]
    v_add_f32 v225, v225, v151
    v_add_f32 v226, v226, v159
    v_add_f32 v227, v227, v167
    v_add_f32 v228, v228, v175
    v_add_f32 v225, v225, v226
    v_add_f32 v227, v227, v228
    s_waitcnt lgkmcnt(2)
    v_mfma_f32_32x32x16_bf16 v[128:143], v[180:183], v[36:39], v[128:143]
    v_add_f32 v225, v225, v227
    v_fma_f32 v221, v221, v222, v225
    v_cvt_pk_bf16_f32 v144, v144, v145
    v_cvt_pk_bf16_f32 v145, v146, v147
    v_cvt_pk_bf16_f32 v146, v148, v149
    v_cvt_pk_bf16_f32 v147, v150, v151
    s_waitcnt lgkmcnt(1)
    v_mfma_f32_32x32x16_bf16 v[128:143], v[184:187], v[40:43], v[128:143]
    v_cvt_pk_bf16_f32 v148, v152, v153
    v_cvt_pk_bf16_f32 v149, v154, v155
    v_cvt_pk_bf16_f32 v150, v156, v157
    v_cvt_pk_bf16_f32 v151, v158, v159
    v_cvt_pk_bf16_f32 v152, v160, v161
    v_cvt_pk_bf16_f32 v153, v162, v163
    s_waitcnt lgkmcnt(0)
    v_mfma_f32_32x32x16_bf16 v[128:143], v[188:191], v[44:47], v[128:143]
    v_cvt_pk_bf16_f32 v154, v164, v165
    v_cvt_pk_bf16_f32 v155, v166, v167
    v_cvt_pk_bf16_f32 v156, v168, v169
    v_cvt_pk_bf16_f32 v157, v170, v171
    v_cvt_pk_bf16_f32 v158, v172, v173
    v_cvt_pk_bf16_f32 v159, v174, v175
    s_waitcnt vmcnt(8)
    s_barrier
    s_add_u32 m0, s92, 0
    s_add_u32 s29, s92, 65536
    buffer_load_dwordx4 v216, s[20:23], s29 offen offset:0 lds
    buffer_load_dwordx4 v217, s[20:23], s29 offen offset:1024 lds
    buffer_load_dwordx4 v218, s[20:23], s29 offen offset:2048 lds
    buffer_load_dwordx4 v219, s[20:23], s29 offen offset:3072 lds
    ds_read_b64_tr_b16 v[176:177], v208 offset:16384
    ds_read_b64_tr_b16 v[178:179], v209 offset:16384
    ds_read_b64_tr_b16 v[180:181], v210 offset:16384
    ds_read_b64_tr_b16 v[182:183], v211 offset:16384
    ds_read_b64_tr_b16 v[184:185], v212 offset:16384
    ds_read_b64_tr_b16 v[186:187], v213 offset:16384
    ds_read_b64_tr_b16 v[188:189], v214 offset:16384
    ds_read_b64_tr_b16 v[190:191], v215 offset:16384
    v_max3_f32 v225, v112, v113, v114
    v_max3_f32 v226, v128, v129, v130
    v_max3_f32 v225, v225, v115, v116
    v_max3_f32 v226, v226, v131, v132
    v_max3_f32 v225, v225, v117, v118
    v_max3_f32 v226, v226, v133, v134
    ds_read_b64_tr_b16 v[192:193], v208 offset:20480
    ds_read_b64_tr_b16 v[194:195], v209 offset:20480
    s_waitcnt lgkmcnt(8)
    v_mfma_f32_32x32x16_bf16 v[48:63], v[176:179], v[144:147], v[48:63]
    v_max3_f32 v225, v225, v119, v120
    v_max3_f32 v226, v226, v135, v136
    v_max3_f32 v225, v225, v121, v122
    v_max3_f32 v226, v226, v137, v138
    ds_read_b64_tr_b16 v[196:197], v210 offset:20480
    ds_read_b64_tr_b16 v[198:199], v211 offset:20480
    s_waitcnt lgkmcnt(8)
    v_mfma_f32_32x32x16_bf16 v[64:79], v[180:183], v[144:147], v[64:79]
    v_max3_f32 v225, v225, v123, v124
    v_max3_f32 v226, v226, v139, v140
    v_max3_f32 v225, v225, v125, v126
    v_max3_f32 v226, v226, v141, v142
    ds_read_b64_tr_b16 v[176:177], v212 offset:20480
    ds_read_b64_tr_b16 v[178:179], v213 offset:20480
    s_waitcnt lgkmcnt(8)
    v_mfma_f32_32x32x16_bf16 v[80:95], v[184:187], v[144:147], v[80:95]
    v_max3_f32 v225, v225, v226, v127
    v_max_f32 v225, v225, v143
    v_mov_b32 v226, v225
    ds_read_b64_tr_b16 v[180:181], v214 offset:20480
    ds_read_b64_tr_b16 v[182:183], v215 offset:20480
    s_waitcnt lgkmcnt(8)
    v_mfma_f32_32x32x16_bf16 v[96:111], v[188:191], v[144:147], v[96:111]
    v_permlane32_swap_b32 v225, v226
    v_max3_f32 v227, v225, v226, v220
    v_sub_f32 v228, v220, v227
    ds_read_b64_tr_b16 v[184:185], v208 offset:24576
    ds_read_b64_tr_b16 v[186:187], v209 offset:24576
    s_waitcnt lgkmcnt(8)
    v_mfma_f32_32x32x16_bf16 v[48:63], v[192:195], v[148:151], v[48:63]
    v_mul_f32 v228, s30, v228
    v_exp_f32 v222, v228
    v_mov_b32 v220, v227
    ds_read_b64_tr_b16 v[188:189], v210 offset:24576
    ds_read_b64_tr_b16 v[190:191], v211 offset:24576
    s_waitcnt lgkmcnt(8)
    v_mfma_f32_32x32x16_bf16 v[64:79], v[196:199], v[148:151], v[64:79]
    v_mul_f32 v224, s30, v220
    v_fma_f32 v112, v112, s30, -v224
    v_fma_f32 v113, v113, s30, -v224
    ds_read_b64_tr_b16 v[192:193], v212 offset:24576
    ds_read_b64_tr_b16 v[194:195], v213 offset:24576
    s_waitcnt lgkmcnt(8)
    v_mfma_f32_32x32x16_bf16 v[80:95], v[176:179], v[148:151], v[80:95]
    v_fma_f32 v114, v114, s30, -v224
    v_fma_f32 v115, v115, s30, -v224
    v_fma_f32 v116, v116, s30, -v224
    ds_read_b64_tr_b16 v[196:197], v214 offset:24576
    ds_read_b64_tr_b16 v[198:199], v215 offset:24576
    s_waitcnt lgkmcnt(8)
    v_mfma_f32_32x32x16_bf16 v[96:111], v[180:183], v[148:151], v[96:111]
    v_fma_f32 v117, v117, s30, -v224
    v_fma_f32 v118, v118, s30, -v224
    v_fma_f32 v119, v119, s30, -v224
    ds_read_b64_tr_b16 v[176:177], v208 offset:28672
    ds_read_b64_tr_b16 v[178:179], v209 offset:28672
    s_waitcnt lgkmcnt(8)
    v_mfma_f32_32x32x16_bf16 v[48:63], v[184:187], v[152:155], v[48:63]
    v_fma_f32 v120, v120, s30, -v224
    v_fma_f32 v121, v121, s30, -v224
    v_fma_f32 v122, v122, s30, -v224
    ds_read_b64_tr_b16 v[180:181], v210 offset:28672
    ds_read_b64_tr_b16 v[182:183], v211 offset:28672
    s_waitcnt lgkmcnt(8)
    v_mfma_f32_32x32x16_bf16 v[64:79], v[188:191], v[152:155], v[64:79]
    v_fma_f32 v123, v123, s30, -v224
    v_fma_f32 v124, v124, s30, -v224
    v_fma_f32 v125, v125, s30, -v224
    ds_read_b64_tr_b16 v[184:185], v212 offset:28672
    ds_read_b64_tr_b16 v[186:187], v213 offset:28672
    s_waitcnt lgkmcnt(8)
    v_mfma_f32_32x32x16_bf16 v[80:95], v[192:195], v[152:155], v[80:95]
    v_fma_f32 v126, v126, s30, -v224
    v_fma_f32 v127, v127, s30, -v224
    v_fma_f32 v128, v128, s30, -v224
    ds_read_b64_tr_b16 v[188:189], v214 offset:28672
    ds_read_b64_tr_b16 v[190:191], v215 offset:28672
    s_waitcnt lgkmcnt(8)
    v_mfma_f32_32x32x16_bf16 v[96:111], v[196:199], v[152:155], v[96:111]
    v_fma_f32 v129, v129, s30, -v224
    v_fma_f32 v130, v130, s30, -v224
    v_fma_f32 v131, v131, s30, -v224
    s_waitcnt lgkmcnt(6)
    v_mfma_f32_32x32x16_bf16 v[48:63], v[176:179], v[156:159], v[48:63]
    v_fma_f32 v132, v132, s30, -v224
    v_fma_f32 v133, v133, s30, -v224
    v_fma_f32 v134, v134, s30, -v224
    s_waitcnt lgkmcnt(4)
    v_mfma_f32_32x32x16_bf16 v[64:79], v[180:183], v[156:159], v[64:79]
    v_fma_f32 v135, v135, s30, -v224
    v_fma_f32 v136, v136, s30, -v224
    v_fma_f32 v137, v137, s30, -v224
    s_waitcnt lgkmcnt(2)
    v_mfma_f32_32x32x16_bf16 v[80:95], v[184:187], v[156:159], v[80:95]
    v_fma_f32 v138, v138, s30, -v224
    v_fma_f32 v139, v139, s30, -v224
    v_fma_f32 v140, v140, s30, -v224
    s_waitcnt lgkmcnt(0)
    v_mfma_f32_32x32x16_bf16 v[96:111], v[188:191], v[156:159], v[96:111]
    v_fma_f32 v141, v141, s30, -v224
    v_fma_f32 v142, v142, s30, -v224
    v_fma_f32 v143, v143, s30, -v224
    s_waitcnt vmcnt(8)
    s_barrier
    s_add_u32 m0, s92, 49152
    s_add_u32 s29, s92, 49152
    buffer_load_dwordx4 v216, s[96:99], s29 offen offset:0 lds
    buffer_load_dwordx4 v217, s[96:99], s29 offen offset:1024 lds
    buffer_load_dwordx4 v218, s[96:99], s29 offen offset:2048 lds
    buffer_load_dwordx4 v219, s[96:99], s29 offen offset:3072 lds
    ds_read_b128 v[176:179], v200 offset:49152
    ds_read_b128 v[180:183], v201 offset:49152
    ds_read_b128 v[184:187], v202 offset:49152
    ds_read_b128 v[188:191], v203 offset:49152
    ds_read_b128 v[192:195], v204 offset:49152
    v_exp_f32 v112, v112
    v_pk_mul_f32 v[48:49], v[48:49], v[222:223] op_sel_hi:[1,0]
    v_exp_f32 v113, v113
    v_pk_mul_f32 v[50:51], v[50:51], v[222:223] op_sel_hi:[1,0]
    v_exp_f32 v114, v114
    v_pk_mul_f32 v[52:53], v[52:53], v[222:223] op_sel_hi:[1,0]
    v_exp_f32 v115, v115
    v_pk_mul_f32 v[54:55], v[54:55], v[222:223] op_sel_hi:[1,0]
    ds_read_b128 v[196:199], v205 offset:49152
    s_waitcnt lgkmcnt(5)
    v_mfma_f32_32x32x16_bf16 v[144:159], v[176:179], v[16:19], 0
    v_exp_f32 v116, v116
    v_pk_mul_f32 v[56:57], v[56:57], v[222:223] op_sel_hi:[1,0]
    v_exp_f32 v117, v117
    v_pk_mul_f32 v[58:59], v[58:59], v[222:223] op_sel_hi:[1,0]
    v_exp_f32 v118, v118
    v_pk_mul_f32 v[60:61], v[60:61], v[222:223] op_sel_hi:[1,0]
    v_exp_f32 v119, v119
    ds_read_b128 v[176:179], v206 offset:49152
    s_waitcnt lgkmcnt(5)
    v_mfma_f32_32x32x16_bf16 v[144:159], v[180:183], v[20:23], v[144:159]
    v_pk_mul_f32 v[62:63], v[62:63], v[222:223] op_sel_hi:[1,0]
    v_exp_f32 v120, v120
    v_pk_mul_f32 v[64:65], v[64:65], v[222:223] op_sel_hi:[1,0]
    v_exp_f32 v121, v121
    v_pk_mul_f32 v[66:67], v[66:67], v[222:223] op_sel_hi:[1,0]
    v_exp_f32 v122, v122
    v_pk_mul_f32 v[68:69], v[68:69], v[222:223] op_sel_hi:[1,0]
    ds_read_b128 v[180:183], v207 offset:49152
    s_waitcnt lgkmcnt(5)
    v_mfma_f32_32x32x16_bf16 v[144:159], v[184:187], v[24:27], v[144:159]
    v_exp_f32 v123, v123
    v_pk_mul_f32 v[70:71], v[70:71], v[222:223] op_sel_hi:[1,0]
    v_exp_f32 v124, v124
    v_pk_mul_f32 v[72:73], v[72:73], v[222:223] op_sel_hi:[1,0]
    v_exp_f32 v125, v125
    v_pk_mul_f32 v[74:75], v[74:75], v[222:223] op_sel_hi:[1,0]
    v_exp_f32 v126, v126
    ds_read_b128 v[184:187], v200 offset:57344
    s_waitcnt lgkmcnt(5)
    v_mfma_f32_32x32x16_bf16 v[144:159], v[188:191], v[28:31], v[144:159]
    v_pk_mul_f32 v[76:77], v[76:77], v[222:223] op_sel_hi:[1,0]
    v_exp_f32 v127, v127
    v_pk_mul_f32 v[78:79], v[78:79], v[222:223] op_sel_hi:[1,0]
    v_exp_f32 v128, v128
    v_pk_mul_f32 v[80:81], v[80:81], v[222:223] op_sel_hi:[1,0]
    v_exp_f32 v129, v129
    v_pk_mul_f32 v[82:83], v[82:83], v[222:223] op_sel_hi:[1,0]
    ds_read_b128 v[188:191], v201 offset:57344
    s_waitcnt lgkmcnt(5)
    v_mfma_f32_32x32x16_bf16 v[144:159], v[192:195], v[32:35], v[144:159]
    v_exp_f32 v130, v130
    v_pk_mul_f32 v[84:85], v[84:85], v[222:223] op_sel_hi:[1,0]
    v_exp_f32 v131, v131
    v_pk_mul_f32 v[86:87], v[86:87], v[222:223] op_sel_hi:[1,0]
    v_exp_f32 v132, v132
    v_pk_mul_f32 v[88:89], v[88:89], v[222:223] op_sel_hi:[1,0]
    v_exp_f32 v133, v133
    ds_read_b128 v[192:195], v202 offset:57344
    s_waitcnt lgkmcnt(5)
    v_mfma_f32_32x32x16_bf16 v[144:159], v[196:199], v[36:39], v[144:159]
    v_pk_mul_f32 v[90:91], v[90:91], v[222:223] op_sel_hi:[1,0]
    v_exp_f32 v134, v134
    v_pk_mul_f32 v[92:93], v[92:93], v[222:223] op_sel_hi:[1,0]
    v_exp_f32 v135, v135
    v_pk_mul_f32 v[94:95], v[94:95], v[222:223] op_sel_hi:[1,0]
    v_exp_f32 v136, v136
    v_pk_mul_f32 v[96:97], v[96:97], v[222:223] op_sel_hi:[1,0]
    ds_read_b128 v[196:199], v203 offset:57344
    s_waitcnt lgkmcnt(5)
    v_mfma_f32_32x32x16_bf16 v[144:159], v[176:179], v[40:43], v[144:159]
    v_exp_f32 v137, v137
    v_pk_mul_f32 v[98:99], v[98:99], v[222:223] op_sel_hi:[1,0]
    v_exp_f32 v138, v138
    v_pk_mul_f32 v[100:101], v[100:101], v[222:223] op_sel_hi:[1,0]
    v_exp_f32 v139, v139
    v_pk_mul_f32 v[102:103], v[102:103], v[222:223] op_sel_hi:[1,0]
    v_exp_f32 v140, v140
    ds_read_b128 v[176:179], v204 offset:57344
    s_waitcnt lgkmcnt(5)
    v_mfma_f32_32x32x16_bf16 v[144:159], v[180:183], v[44:47], v[144:159]
    v_pk_mul_f32 v[104:105], v[104:105], v[222:223] op_sel_hi:[1,0]
    v_exp_f32 v141, v141
    v_pk_mul_f32 v[106:107], v[106:107], v[222:223] op_sel_hi:[1,0]
    v_exp_f32 v142, v142
    v_pk_mul_f32 v[108:109], v[108:109], v[222:223] op_sel_hi:[1,0]
    v_exp_f32 v143, v143
    v_pk_mul_f32 v[110:111], v[110:111], v[222:223] op_sel_hi:[1,0]
    ds_read_b128 v[180:183], v205 offset:57344
    s_waitcnt lgkmcnt(5)
    v_mfma_f32_32x32x16_bf16 v[160:175], v[184:187], v[16:19], 0
    v_add_f32 v225, v112, v113
    v_add_f32 v226, v120, v121
    v_add_f32 v227, v128, v129
    v_add_f32 v228, v136, v137
    v_add_f32 v225, v225, v114
    v_add_f32 v226, v226, v122
    ds_read_b128 v[184:187], v206 offset:57344
    s_waitcnt lgkmcnt(5)
    v_mfma_f32_32x32x16_bf16 v[160:175], v[188:191], v[20:23], v[160:175]
    v_add_f32 v227, v227, v130
    v_add_f32 v228, v228, v138
    v_add_f32 v225, v225, v115
    v_add_f32 v226, v226, v123
    v_add_f32 v227, v227, v131
    v_add_f32 v228, v228, v139
    ds_read_b128 v[188:191], v207 offset:57344
    s_waitcnt lgkmcnt(5)
    v_mfma_f32_32x32x16_bf16 v[160:175], v[192:195], v[24:27], v[160:175]
    v_add_f32 v225, v225, v116
    v_add_f32 v226, v226, v124
    v_add_f32 v227, v227, v132
    v_add_f32 v228, v228, v140
    v_add_f32 v225, v225, v117
    v_add_f32 v226, v226, v125
    s_waitcnt lgkmcnt(4)
    v_mfma_f32_32x32x16_bf16 v[160:175], v[196:199], v[28:31], v[160:175]
    v_add_f32 v227, v227, v133
    v_add_f32 v228, v228, v141
    v_add_f32 v225, v225, v118
    v_add_f32 v226, v226, v126
    v_add_f32 v227, v227, v134
    v_add_f32 v228, v228, v142
    s_waitcnt lgkmcnt(3)
    v_mfma_f32_32x32x16_bf16 v[160:175], v[176:179], v[32:35], v[160:175]
    v_add_f32 v225, v225, v119
    v_add_f32 v226, v226, v127
    v_add_f32 v227, v227, v135
    v_add_f32 v228, v228, v143
    v_add_f32 v225, v225, v226
    v_add_f32 v227, v227, v228
    s_waitcnt lgkmcnt(2)
    v_mfma_f32_32x32x16_bf16 v[160:175], v[180:183], v[36:39], v[160:175]
    v_add_f32 v225, v225, v227
    v_fma_f32 v221, v221, v222, v225
    v_cvt_pk_bf16_f32 v112, v112, v113
    v_cvt_pk_bf16_f32 v113, v114, v115
    v_cvt_pk_bf16_f32 v114, v116, v117
    v_cvt_pk_bf16_f32 v115, v118, v119
    s_waitcnt lgkmcnt(1)
    v_mfma_f32_32x32x16_bf16 v[160:175], v[184:187], v[40:43], v[160:175]
    v_cvt_pk_bf16_f32 v116, v120, v121
    v_cvt_pk_bf16_f32 v117, v122, v123
    v_cvt_pk_bf16_f32 v118, v124, v125
    v_cvt_pk_bf16_f32 v119, v126, v127
    v_cvt_pk_bf16_f32 v120, v128, v129
    v_cvt_pk_bf16_f32 v121, v130, v131
    s_waitcnt lgkmcnt(0)
    v_mfma_f32_32x32x16_bf16 v[160:175], v[188:191], v[44:47], v[160:175]
    v_cvt_pk_bf16_f32 v122, v132, v133
    v_cvt_pk_bf16_f32 v123, v134, v135
    v_cvt_pk_bf16_f32 v124, v136, v137
    v_cvt_pk_bf16_f32 v125, v138, v139
    v_cvt_pk_bf16_f32 v126, v140, v141
    v_cvt_pk_bf16_f32 v127, v142, v143
    s_waitcnt vmcnt(8)
    s_barrier
    s_add_u32 m0, s92, 16384
    s_add_u32 s29, s92, 81920
    buffer_load_dwordx4 v216, s[20:23], s29 offen offset:0 lds
    buffer_load_dwordx4 v217, s[20:23], s29 offen offset:1024 lds
    buffer_load_dwordx4 v218, s[20:23], s29 offen offset:2048 lds
    buffer_load_dwordx4 v219, s[20:23], s29 offen offset:3072 lds
    ds_read_b64_tr_b16 v[176:177], v208 offset:32768
    ds_read_b64_tr_b16 v[178:179], v209 offset:32768
    ds_read_b64_tr_b16 v[180:181], v210 offset:32768
    ds_read_b64_tr_b16 v[182:183], v211 offset:32768
    ds_read_b64_tr_b16 v[184:185], v212 offset:32768
    ds_read_b64_tr_b16 v[186:187], v213 offset:32768
    ds_read_b64_tr_b16 v[188:189], v214 offset:32768
    ds_read_b64_tr_b16 v[190:191], v215 offset:32768
    v_max3_f32 v225, v144, v145, v146
    v_max3_f32 v226, v160, v161, v162
    v_max3_f32 v225, v225, v147, v148
    v_max3_f32 v226, v226, v163, v164
    v_max3_f32 v225, v225, v149, v150
    v_max3_f32 v226, v226, v165, v166
    ds_read_b64_tr_b16 v[192:193], v208 offset:36864
    ds_read_b64_tr_b16 v[194:195], v209 offset:36864
    s_waitcnt lgkmcnt(8)
    v_mfma_f32_32x32x16_bf16 v[48:63], v[176:179], v[112:115], v[48:63]
    v_max3_f32 v225, v225, v151, v152
    v_max3_f32 v226, v226, v167, v168
    v_max3_f32 v225, v225, v153, v154
    v_max3_f32 v226, v226, v169, v170
    ds_read_b64_tr_b16 v[196:197], v210 offset:36864
    ds_read_b64_tr_b16 v[198:199], v211 offset:36864
    s_waitcnt lgkmcnt(8)
    v_mfma_f32_32x32x16_bf16 v[64:79], v[180:183], v[112:115], v[64:79]
    v_max3_f32 v225, v225, v155, v156
    v_max3_f32 v226, v226, v171, v172
    v_max3_f32 v225, v225, v157, v158
    v_max3_f32 v226, v226, v173, v174
    ds_read_b64_tr_b16 v[176:177], v212 offset:36864
    ds_read_b64_tr_b16 v[178:179], v213 offset:36864
    s_waitcnt lgkmcnt(8)
    v_mfma_f32_32x32x16_bf16 v[80:95], v[184:187], v[112:115], v[80:95]
    v_max3_f32 v225, v225, v226, v159
    v_max_f32 v225, v225, v175
    v_mov_b32 v226, v225
    ds_read_b64_tr_b16 v[180:181], v214 offset:36864
    ds_read_b64_tr_b16 v[182:183], v215 offset:36864
    s_waitcnt lgkmcnt(8)
    v_mfma_f32_32x32x16_bf16 v[96:111], v[188:191], v[112:115], v[96:111]
    v_permlane32_swap_b32 v225, v226
    v_max3_f32 v227, v225, v226, v220
    v_sub_f32 v228, v220, v227
    ds_read_b64_tr_b16 v[184:185], v208 offset:40960
    ds_read_b64_tr_b16 v[186:187], v209 offset:40960
    s_waitcnt lgkmcnt(8)
    v_mfma_f32_32x32x16_bf16 v[48:63], v[192:195], v[116:119], v[48:63]
    v_mul_f32 v228, s30, v228
    v_exp_f32 v222, v228
    v_mov_b32 v220, v227
    ds_read_b64_tr_b16 v[188:189], v210 offset:40960
    ds_read_b64_tr_b16 v[190:191], v211 offset:40960
    s_waitcnt lgkmcnt(8)
    v_mfma_f32_32x32x16_bf16 v[64:79], v[196:199], v[116:119], v[64:79]
    v_mul_f32 v224, s30, v220
    v_fma_f32 v144, v144, s30, -v224
    v_fma_f32 v145, v145, s30, -v224
    ds_read_b64_tr_b16 v[192:193], v212 offset:40960
    ds_read_b64_tr_b16 v[194:195], v213 offset:40960
    s_waitcnt lgkmcnt(8)
    v_mfma_f32_32x32x16_bf16 v[80:95], v[176:179], v[116:119], v[80:95]
    v_fma_f32 v146, v146, s30, -v224
    v_fma_f32 v147, v147, s30, -v224
    v_fma_f32 v148, v148, s30, -v224
    ds_read_b64_tr_b16 v[196:197], v214 offset:40960
    ds_read_b64_tr_b16 v[198:199], v215 offset:40960
    s_waitcnt lgkmcnt(8)
    v_mfma_f32_32x32x16_bf16 v[96:111], v[180:183], v[116:119], v[96:111]
    v_fma_f32 v149, v149, s30, -v224
    v_fma_f32 v150, v150, s30, -v224
    v_fma_f32 v151, v151, s30, -v224
    ds_read_b64_tr_b16 v[176:177], v208 offset:45056
    ds_read_b64_tr_b16 v[178:179], v209 offset:45056
    s_waitcnt lgkmcnt(8)
    v_mfma_f32_32x32x16_bf16 v[48:63], v[184:187], v[120:123], v[48:63]
    v_fma_f32 v152, v152, s30, -v224
    v_fma_f32 v153, v153, s30, -v224
    v_fma_f32 v154, v154, s30, -v224
    ds_read_b64_tr_b16 v[180:181], v210 offset:45056
    ds_read_b64_tr_b16 v[182:183], v211 offset:45056
    s_waitcnt lgkmcnt(8)
    v_mfma_f32_32x32x16_bf16 v[64:79], v[188:191], v[120:123], v[64:79]
    v_fma_f32 v155, v155, s30, -v224
    v_fma_f32 v156, v156, s30, -v224
    v_fma_f32 v157, v157, s30, -v224
    ds_read_b64_tr_b16 v[184:185], v212 offset:45056
    ds_read_b64_tr_b16 v[186:187], v213 offset:45056
    s_waitcnt lgkmcnt(8)
    v_mfma_f32_32x32x16_bf16 v[80:95], v[192:195], v[120:123], v[80:95]
    v_fma_f32 v158, v158, s30, -v224
    v_fma_f32 v159, v159, s30, -v224
    v_fma_f32 v160, v160, s30, -v224
    ds_read_b64_tr_b16 v[188:189], v214 offset:45056
    ds_read_b64_tr_b16 v[190:191], v215 offset:45056
    s_waitcnt lgkmcnt(8)
    v_mfma_f32_32x32x16_bf16 v[96:111], v[196:199], v[120:123], v[96:111]
    v_fma_f32 v161, v161, s30, -v224
    v_fma_f32 v162, v162, s30, -v224
    v_fma_f32 v163, v163, s30, -v224
    s_waitcnt lgkmcnt(6)
    v_mfma_f32_32x32x16_bf16 v[48:63], v[176:179], v[124:127], v[48:63]
    v_fma_f32 v164, v164, s30, -v224
    v_fma_f32 v165, v165, s30, -v224
    v_fma_f32 v166, v166, s30, -v224
    s_waitcnt lgkmcnt(4)
    v_mfma_f32_32x32x16_bf16 v[64:79], v[180:183], v[124:127], v[64:79]
    v_fma_f32 v167, v167, s30, -v224
    v_fma_f32 v168, v168, s30, -v224
    v_fma_f32 v169, v169, s30, -v224
    s_waitcnt lgkmcnt(2)
    v_mfma_f32_32x32x16_bf16 v[80:95], v[184:187], v[124:127], v[80:95]
    v_fma_f32 v170, v170, s30, -v224
    v_fma_f32 v171, v171, s30, -v224
    v_fma_f32 v172, v172, s30, -v224
    s_waitcnt lgkmcnt(0)
    v_mfma_f32_32x32x16_bf16 v[96:111], v[188:191], v[124:127], v[96:111]
    v_fma_f32 v173, v173, s30, -v224
    v_fma_f32 v174, v174, s30, -v224
    v_fma_f32 v175, v175, s30, -v224
    v_subrev_u32 v200, 16384, v200
    v_subrev_u32 v201, 16384, v201
    v_subrev_u32 v202, 16384, v202
    v_subrev_u32 v203, 16384, v203
    v_subrev_u32 v204, 16384, v204
    v_subrev_u32 v205, 16384, v205
    v_subrev_u32 v206, 16384, v206
    v_subrev_u32 v207, 16384, v207
    s_waitcnt vmcnt(8)
    s_barrier
    s_add_u32 m0, s92, 65536
    s_add_u32 s29, s92, 65536
    buffer_load_dwordx4 v216, s[96:99], s29 offen offset:0 lds
    buffer_load_dwordx4 v217, s[96:99], s29 offen offset:1024 lds
    buffer_load_dwordx4 v218, s[96:99], s29 offen offset:2048 lds
    buffer_load_dwordx4 v219, s[96:99], s29 offen offset:3072 lds
    ds_read_b128 v[176:179], v200 offset:0
    ds_read_b128 v[180:183], v201 offset:0
    ds_read_b128 v[184:187], v202 offset:0
    ds_read_b128 v[188:191], v203 offset:0
    ds_read_b128 v[192:195], v204 offset:0
    v_exp_f32 v144, v144
    v_pk_mul_f32 v[48:49], v[48:49], v[222:223] op_sel_hi:[1,0]
    v_exp_f32 v145, v145
    v_pk_mul_f32 v[50:51], v[50:51], v[222:223] op_sel_hi:[1,0]
    v_exp_f32 v146, v146
    v_pk_mul_f32 v[52:53], v[52:53], v[222:223] op_sel_hi:[1,0]
    v_exp_f32 v147, v147
    v_pk_mul_f32 v[54:55], v[54:55], v[222:223] op_sel_hi:[1,0]
    ds_read_b128 v[196:199], v205 offset:0
    s_waitcnt lgkmcnt(5)
    v_mfma_f32_32x32x16_bf16 v[112:127], v[176:179], v[16:19], 0
    v_exp_f32 v148, v148
    v_pk_mul_f32 v[56:57], v[56:57], v[222:223] op_sel_hi:[1,0]
    v_exp_f32 v149, v149
    v_pk_mul_f32 v[58:59], v[58:59], v[222:223] op_sel_hi:[1,0]
    v_exp_f32 v150, v150
    v_pk_mul_f32 v[60:61], v[60:61], v[222:223] op_sel_hi:[1,0]
    v_exp_f32 v151, v151
    ds_read_b128 v[176:179], v206 offset:0
    s_waitcnt lgkmcnt(5)
    v_mfma_f32_32x32x16_bf16 v[112:127], v[180:183], v[20:23], v[112:127]
    v_pk_mul_f32 v[62:63], v[62:63], v[222:223] op_sel_hi:[1,0]
    v_exp_f32 v152, v152
    v_pk_mul_f32 v[64:65], v[64:65], v[222:223] op_sel_hi:[1,0]
    v_exp_f32 v153, v153
    v_pk_mul_f32 v[66:67], v[66:67], v[222:223] op_sel_hi:[1,0]
    v_exp_f32 v154, v154
    v_pk_mul_f32 v[68:69], v[68:69], v[222:223] op_sel_hi:[1,0]
    ds_read_b128 v[180:183], v207 offset:0
    s_waitcnt lgkmcnt(5)
    v_mfma_f32_32x32x16_bf16 v[112:127], v[184:187], v[24:27], v[112:127]
    v_exp_f32 v155, v155
    v_pk_mul_f32 v[70:71], v[70:71], v[222:223] op_sel_hi:[1,0]
    v_exp_f32 v156, v156
    v_pk_mul_f32 v[72:73], v[72:73], v[222:223] op_sel_hi:[1,0]
    v_exp_f32 v157, v157
    v_pk_mul_f32 v[74:75], v[74:75], v[222:223] op_sel_hi:[1,0]
    v_exp_f32 v158, v158
    ds_read_b128 v[184:187], v200 offset:8192
    s_waitcnt lgkmcnt(5)
    v_mfma_f32_32x32x16_bf16 v[112:127], v[188:191], v[28:31], v[112:127]
    v_pk_mul_f32 v[76:77], v[76:77], v[222:223] op_sel_hi:[1,0]
    v_exp_f32 v159, v159
    v_pk_mul_f32 v[78:79], v[78:79], v[222:223] op_sel_hi:[1,0]
    v_exp_f32 v160, v160
    v_pk_mul_f32 v[80:81], v[80:81], v[222:223] op_sel_hi:[1,0]
    v_exp_f32 v161, v161
    v_pk_mul_f32 v[82:83], v[82:83], v[222:223] op_sel_hi:[1,0]
    ds_read_b128 v[188:191], v201 offset:8192
    s_waitcnt lgkmcnt(5)
    v_mfma_f32_32x32x16_bf16 v[112:127], v[192:195], v[32:35], v[112:127]
    v_exp_f32 v162, v162
    v_pk_mul_f32 v[84:85], v[84:85], v[222:223] op_sel_hi:[1,0]
    v_exp_f32 v163, v163
    v_pk_mul_f32 v[86:87], v[86:87], v[222:223] op_sel_hi:[1,0]
    v_exp_f32 v164, v164
    v_pk_mul_f32 v[88:89], v[88:89], v[222:223] op_sel_hi:[1,0]
    v_exp_f32 v165, v165
    ds_read_b128 v[192:195], v202 offset:8192
    s_waitcnt lgkmcnt(5)
    v_mfma_f32_32x32x16_bf16 v[112:127], v[196:199], v[36:39], v[112:127]
    v_pk_mul_f32 v[90:91], v[90:91], v[222:223] op_sel_hi:[1,0]
    v_exp_f32 v166, v166
    v_pk_mul_f32 v[92:93], v[92:93], v[222:223] op_sel_hi:[1,0]
    v_exp_f32 v167, v167
    v_pk_mul_f32 v[94:95], v[94:95], v[222:223] op_sel_hi:[1,0]
    v_exp_f32 v168, v168
    v_pk_mul_f32 v[96:97], v[96:97], v[222:223] op_sel_hi:[1,0]
    ds_read_b128 v[196:199], v203 offset:8192
    s_waitcnt lgkmcnt(5)
    v_mfma_f32_32x32x16_bf16 v[112:127], v[176:179], v[40:43], v[112:127]
    v_exp_f32 v169, v169
    v_pk_mul_f32 v[98:99], v[98:99], v[222:223] op_sel_hi:[1,0]
    v_exp_f32 v170, v170
    v_pk_mul_f32 v[100:101], v[100:101], v[222:223] op_sel_hi:[1,0]
    v_exp_f32 v171, v171
    v_pk_mul_f32 v[102:103], v[102:103], v[222:223] op_sel_hi:[1,0]
    v_exp_f32 v172, v172
    ds_read_b128 v[176:179], v204 offset:8192
    s_waitcnt lgkmcnt(5)
    v_mfma_f32_32x32x16_bf16 v[112:127], v[180:183], v[44:47], v[112:127]
    v_pk_mul_f32 v[104:105], v[104:105], v[222:223] op_sel_hi:[1,0]
    v_exp_f32 v173, v173
    v_pk_mul_f32 v[106:107], v[106:107], v[222:223] op_sel_hi:[1,0]
    v_exp_f32 v174, v174
    v_pk_mul_f32 v[108:109], v[108:109], v[222:223] op_sel_hi:[1,0]
    v_exp_f32 v175, v175
    v_pk_mul_f32 v[110:111], v[110:111], v[222:223] op_sel_hi:[1,0]
    ds_read_b128 v[180:183], v205 offset:8192
    s_waitcnt lgkmcnt(5)
    v_mfma_f32_32x32x16_bf16 v[128:143], v[184:187], v[16:19], 0
    v_add_f32 v225, v144, v145
    v_add_f32 v226, v152, v153
    v_add_f32 v227, v160, v161
    v_add_f32 v228, v168, v169
    v_add_f32 v225, v225, v146
    v_add_f32 v226, v226, v154
    ds_read_b128 v[184:187], v206 offset:8192
    s_waitcnt lgkmcnt(5)
    v_mfma_f32_32x32x16_bf16 v[128:143], v[188:191], v[20:23], v[128:143]
    v_add_f32 v227, v227, v162
    v_add_f32 v228, v228, v170
    v_add_f32 v225, v225, v147
    v_add_f32 v226, v226, v155
    v_add_f32 v227, v227, v163
    v_add_f32 v228, v228, v171
    ds_read_b128 v[188:191], v207 offset:8192
    s_waitcnt lgkmcnt(5)
    v_mfma_f32_32x32x16_bf16 v[128:143], v[192:195], v[24:27], v[128:143]
    v_add_f32 v225, v225, v148
    v_add_f32 v226, v226, v156
    v_add_f32 v227, v227, v164
    v_add_f32 v228, v228, v172
    v_add_f32 v225, v225, v149
    v_add_f32 v226, v226, v157
    s_waitcnt lgkmcnt(4)
    v_mfma_f32_32x32x16_bf16 v[128:143], v[196:199], v[28:31], v[128:143]
    v_add_f32 v227, v227, v165
    v_add_f32 v228, v228, v173
    v_add_f32 v225, v225, v150
    v_add_f32 v226, v226, v158
    v_add_f32 v227, v227, v166
    v_add_f32 v228, v228, v174
    s_waitcnt lgkmcnt(3)
    v_mfma_f32_32x32x16_bf16 v[128:143], v[176:179], v[32:35], v[128:143]
    v_add_f32 v225, v225, v151
    v_add_f32 v226, v226, v159
    v_add_f32 v227, v227, v167
    v_add_f32 v228, v228, v175
    v_add_f32 v225, v225, v226
    v_add_f32 v227, v227, v228
    s_waitcnt lgkmcnt(2)
    v_mfma_f32_32x32x16_bf16 v[128:143], v[180:183], v[36:39], v[128:143]
    v_add_f32 v225, v225, v227
    v_fma_f32 v221, v221, v222, v225
    v_cvt_pk_bf16_f32 v144, v144, v145
    v_cvt_pk_bf16_f32 v145, v146, v147
    v_cvt_pk_bf16_f32 v146, v148, v149
    v_cvt_pk_bf16_f32 v147, v150, v151
    s_waitcnt lgkmcnt(1)
    v_mfma_f32_32x32x16_bf16 v[128:143], v[184:187], v[40:43], v[128:143]
    v_cvt_pk_bf16_f32 v148, v152, v153
    v_cvt_pk_bf16_f32 v149, v154, v155
    v_cvt_pk_bf16_f32 v150, v156, v157
    v_cvt_pk_bf16_f32 v151, v158, v159
    v_cvt_pk_bf16_f32 v152, v160, v161
    v_cvt_pk_bf16_f32 v153, v162, v163
    s_waitcnt lgkmcnt(0)
    v_mfma_f32_32x32x16_bf16 v[128:143], v[188:191], v[44:47], v[128:143]
    v_cvt_pk_bf16_f32 v154, v164, v165
    v_cvt_pk_bf16_f32 v155, v166, v167
    v_cvt_pk_bf16_f32 v156, v168, v169
    v_cvt_pk_bf16_f32 v157, v170, v171
    v_cvt_pk_bf16_f32 v158, v172, v173
    v_cvt_pk_bf16_f32 v159, v174, v175
    s_waitcnt vmcnt(8)
    s_barrier
    s_add_u32 m0, s92, 32768
    s_add_u32 s29, s92, 98304
    buffer_load_dwordx4 v216, s[20:23], s29 offen offset:0 lds
    buffer_load_dwordx4 v217, s[20:23], s29 offen offset:1024 lds
    buffer_load_dwordx4 v218, s[20:23], s29 offen offset:2048 lds
    buffer_load_dwordx4 v219, s[20:23], s29 offen offset:3072 lds
    ds_read_b64_tr_b16 v[176:177], v208 offset:49152
    ds_read_b64_tr_b16 v[178:179], v209 offset:49152
    ds_read_b64_tr_b16 v[180:181], v210 offset:49152
    ds_read_b64_tr_b16 v[182:183], v211 offset:49152
    ds_read_b64_tr_b16 v[184:185], v212 offset:49152
    ds_read_b64_tr_b16 v[186:187], v213 offset:49152
    ds_read_b64_tr_b16 v[188:189], v214 offset:49152
    ds_read_b64_tr_b16 v[190:191], v215 offset:49152
    v_max3_f32 v225, v112, v113, v114
    v_max3_f32 v226, v128, v129, v130
    v_max3_f32 v225, v225, v115, v116
    v_max3_f32 v226, v226, v131, v132
    v_max3_f32 v225, v225, v117, v118
    v_max3_f32 v226, v226, v133, v134
    ds_read_b64_tr_b16 v[192:193], v208 offset:53248
    ds_read_b64_tr_b16 v[194:195], v209 offset:53248
    s_waitcnt lgkmcnt(8)
    v_mfma_f32_32x32x16_bf16 v[48:63], v[176:179], v[144:147], v[48:63]
    v_max3_f32 v225, v225, v119, v120
    v_max3_f32 v226, v226, v135, v136
    v_max3_f32 v225, v225, v121, v122
    v_max3_f32 v226, v226, v137, v138
    ds_read_b64_tr_b16 v[196:197], v210 offset:53248
    ds_read_b64_tr_b16 v[198:199], v211 offset:53248
    s_waitcnt lgkmcnt(8)
    v_mfma_f32_32x32x16_bf16 v[64:79], v[180:183], v[144:147], v[64:79]
    v_max3_f32 v225, v225, v123, v124
    v_max3_f32 v226, v226, v139, v140
    v_max3_f32 v225, v225, v125, v126
    v_max3_f32 v226, v226, v141, v142
    ds_read_b64_tr_b16 v[176:177], v212 offset:53248
    ds_read_b64_tr_b16 v[178:179], v213 offset:53248
    s_waitcnt lgkmcnt(8)
    v_mfma_f32_32x32x16_bf16 v[80:95], v[184:187], v[144:147], v[80:95]
    v_max3_f32 v225, v225, v226, v127
    v_max_f32 v225, v225, v143
    v_mov_b32 v226, v225
    ds_read_b64_tr_b16 v[180:181], v214 offset:53248
    ds_read_b64_tr_b16 v[182:183], v215 offset:53248
    s_waitcnt lgkmcnt(8)
    v_mfma_f32_32x32x16_bf16 v[96:111], v[188:191], v[144:147], v[96:111]
    v_permlane32_swap_b32 v225, v226
    v_max3_f32 v227, v225, v226, v220
    v_sub_f32 v228, v220, v227
    ds_read_b64_tr_b16 v[184:185], v208 offset:57344
    ds_read_b64_tr_b16 v[186:187], v209 offset:57344
    s_waitcnt lgkmcnt(8)
    v_mfma_f32_32x32x16_bf16 v[48:63], v[192:195], v[148:151], v[48:63]
    v_mul_f32 v228, s30, v228
    v_exp_f32 v222, v228
    v_mov_b32 v220, v227
    ds_read_b64_tr_b16 v[188:189], v210 offset:57344
    ds_read_b64_tr_b16 v[190:191], v211 offset:57344
    s_waitcnt lgkmcnt(8)
    v_mfma_f32_32x32x16_bf16 v[64:79], v[196:199], v[148:151], v[64:79]
    v_mul_f32 v224, s30, v220
    v_fma_f32 v112, v112, s30, -v224
    v_fma_f32 v113, v113, s30, -v224
    ds_read_b64_tr_b16 v[192:193], v212 offset:57344
    ds_read_b64_tr_b16 v[194:195], v213 offset:57344
    s_waitcnt lgkmcnt(8)
    v_mfma_f32_32x32x16_bf16 v[80:95], v[176:179], v[148:151], v[80:95]
    v_fma_f32 v114, v114, s30, -v224
    v_fma_f32 v115, v115, s30, -v224
    v_fma_f32 v116, v116, s30, -v224
    ds_read_b64_tr_b16 v[196:197], v214 offset:57344
    ds_read_b64_tr_b16 v[198:199], v215 offset:57344
    s_waitcnt lgkmcnt(8)
    v_mfma_f32_32x32x16_bf16 v[96:111], v[180:183], v[148:151], v[96:111]
    v_fma_f32 v117, v117, s30, -v224
    v_fma_f32 v118, v118, s30, -v224
    v_fma_f32 v119, v119, s30, -v224
    ds_read_b64_tr_b16 v[176:177], v208 offset:61440
    ds_read_b64_tr_b16 v[178:179], v209 offset:61440
    s_waitcnt lgkmcnt(8)
    v_mfma_f32_32x32x16_bf16 v[48:63], v[184:187], v[152:155], v[48:63]
    v_fma_f32 v120, v120, s30, -v224
    v_fma_f32 v121, v121, s30, -v224
    v_fma_f32 v122, v122, s30, -v224
    ds_read_b64_tr_b16 v[180:181], v210 offset:61440
    ds_read_b64_tr_b16 v[182:183], v211 offset:61440
    s_waitcnt lgkmcnt(8)
    v_mfma_f32_32x32x16_bf16 v[64:79], v[188:191], v[152:155], v[64:79]
    v_fma_f32 v123, v123, s30, -v224
    v_fma_f32 v124, v124, s30, -v224
    v_fma_f32 v125, v125, s30, -v224
    ds_read_b64_tr_b16 v[184:185], v212 offset:61440
    ds_read_b64_tr_b16 v[186:187], v213 offset:61440
    s_waitcnt lgkmcnt(8)
    v_mfma_f32_32x32x16_bf16 v[80:95], v[192:195], v[152:155], v[80:95]
    v_fma_f32 v126, v126, s30, -v224
    v_fma_f32 v127, v127, s30, -v224
    v_fma_f32 v128, v128, s30, -v224
    ds_read_b64_tr_b16 v[188:189], v214 offset:61440
    ds_read_b64_tr_b16 v[190:191], v215 offset:61440
    s_waitcnt lgkmcnt(8)
    v_mfma_f32_32x32x16_bf16 v[96:111], v[196:199], v[152:155], v[96:111]
    v_fma_f32 v129, v129, s30, -v224
    v_fma_f32 v130, v130, s30, -v224
    v_fma_f32 v131, v131, s30, -v224
    s_waitcnt lgkmcnt(6)
    v_mfma_f32_32x32x16_bf16 v[48:63], v[176:179], v[156:159], v[48:63]
    v_fma_f32 v132, v132, s30, -v224
    v_fma_f32 v133, v133, s30, -v224
    v_fma_f32 v134, v134, s30, -v224
    s_waitcnt lgkmcnt(4)
    v_mfma_f32_32x32x16_bf16 v[64:79], v[180:183], v[156:159], v[64:79]
    v_fma_f32 v135, v135, s30, -v224
    v_fma_f32 v136, v136, s30, -v224
    v_fma_f32 v137, v137, s30, -v224
    s_waitcnt lgkmcnt(2)
    v_mfma_f32_32x32x16_bf16 v[80:95], v[184:187], v[156:159], v[80:95]
    v_fma_f32 v138, v138, s30, -v224
    v_fma_f32 v139, v139, s30, -v224
    v_fma_f32 v140, v140, s30, -v224
    s_waitcnt lgkmcnt(0)
    v_mfma_f32_32x32x16_bf16 v[96:111], v[188:191], v[156:159], v[96:111]
    v_fma_f32 v141, v141, s30, -v224
    v_fma_f32 v142, v142, s30, -v224
    v_fma_f32 v143, v143, s30, -v224
    s_waitcnt vmcnt(8)
    s_barrier
    s_add_u32 m0, s92, 0
    s_add_u32 s29, s92, 81920
    buffer_load_dwordx4 v216, s[96:99], s29 offen offset:0 lds
    buffer_load_dwordx4 v217, s[96:99], s29 offen offset:1024 lds
    buffer_load_dwordx4 v218, s[96:99], s29 offen offset:2048 lds
    buffer_load_dwordx4 v219, s[96:99], s29 offen offset:3072 lds
    ds_read_b128 v[176:179], v200 offset:16384
    ds_read_b128 v[180:183], v201 offset:16384
    ds_read_b128 v[184:187], v202 offset:16384
    ds_read_b128 v[188:191], v203 offset:16384
    ds_read_b128 v[192:195], v204 offset:16384
    v_exp_f32 v112, v112
    v_pk_mul_f32 v[48:49], v[48:49], v[222:223] op_sel_hi:[1,0]
    v_exp_f32 v113, v113
    v_pk_mul_f32 v[50:51], v[50:51], v[222:223] op_sel_hi:[1,0]
    v_exp_f32 v114, v114
    v_pk_mul_f32 v[52:53], v[52:53], v[222:223] op_sel_hi:[1,0]
    v_exp_f32 v115, v115
    v_pk_mul_f32 v[54:55], v[54:55], v[222:223] op_sel_hi:[1,0]
    ds_read_b128 v[196:199], v205 offset:16384
    s_waitcnt lgkmcnt(5)
    v_mfma_f32_32x32x16_bf16 v[144:159], v[176:179], v[16:19], 0
    v_exp_f32 v116, v116
    v_pk_mul_f32 v[56:57], v[56:57], v[222:223] op_sel_hi:[1,0]
    v_exp_f32 v117, v117
    v_pk_mul_f32 v[58:59], v[58:59], v[222:223] op_sel_hi:[1,0]
    v_exp_f32 v118, v118
    v_pk_mul_f32 v[60:61], v[60:61], v[222:223] op_sel_hi:[1,0]
    v_exp_f32 v119, v119
    ds_read_b128 v[176:179], v206 offset:16384
    s_waitcnt lgkmcnt(5)
    v_mfma_f32_32x32x16_bf16 v[144:159], v[180:183], v[20:23], v[144:159]
    v_pk_mul_f32 v[62:63], v[62:63], v[222:223] op_sel_hi:[1,0]
    v_exp_f32 v120, v120
    v_pk_mul_f32 v[64:65], v[64:65], v[222:223] op_sel_hi:[1,0]
    v_exp_f32 v121, v121
    v_pk_mul_f32 v[66:67], v[66:67], v[222:223] op_sel_hi:[1,0]
    v_exp_f32 v122, v122
    v_pk_mul_f32 v[68:69], v[68:69], v[222:223] op_sel_hi:[1,0]
    ds_read_b128 v[180:183], v207 offset:16384
    s_waitcnt lgkmcnt(5)
    v_mfma_f32_32x32x16_bf16 v[144:159], v[184:187], v[24:27], v[144:159]
    v_exp_f32 v123, v123
    v_pk_mul_f32 v[70:71], v[70:71], v[222:223] op_sel_hi:[1,0]
    v_exp_f32 v124, v124
    v_pk_mul_f32 v[72:73], v[72:73], v[222:223] op_sel_hi:[1,0]
    v_exp_f32 v125, v125
    v_pk_mul_f32 v[74:75], v[74:75], v[222:223] op_sel_hi:[1,0]
    v_exp_f32 v126, v126
    ds_read_b128 v[184:187], v200 offset:24576
    s_waitcnt lgkmcnt(5)
    v_mfma_f32_32x32x16_bf16 v[144:159], v[188:191], v[28:31], v[144:159]
    v_pk_mul_f32 v[76:77], v[76:77], v[222:223] op_sel_hi:[1,0]
    v_exp_f32 v127, v127
    v_pk_mul_f32 v[78:79], v[78:79], v[222:223] op_sel_hi:[1,0]
    v_exp_f32 v128, v128
    v_pk_mul_f32 v[80:81], v[80:81], v[222:223] op_sel_hi:[1,0]
    v_exp_f32 v129, v129
    v_pk_mul_f32 v[82:83], v[82:83], v[222:223] op_sel_hi:[1,0]
    ds_read_b128 v[188:191], v201 offset:24576
    s_waitcnt lgkmcnt(5)
    v_mfma_f32_32x32x16_bf16 v[144:159], v[192:195], v[32:35], v[144:159]
    v_exp_f32 v130, v130
    v_pk_mul_f32 v[84:85], v[84:85], v[222:223] op_sel_hi:[1,0]
    v_exp_f32 v131, v131
    v_pk_mul_f32 v[86:87], v[86:87], v[222:223] op_sel_hi:[1,0]
    v_exp_f32 v132, v132
    v_pk_mul_f32 v[88:89], v[88:89], v[222:223] op_sel_hi:[1,0]
    v_exp_f32 v133, v133
    ds_read_b128 v[192:195], v202 offset:24576
    s_waitcnt lgkmcnt(5)
    v_mfma_f32_32x32x16_bf16 v[144:159], v[196:199], v[36:39], v[144:159]
    v_pk_mul_f32 v[90:91], v[90:91], v[222:223] op_sel_hi:[1,0]
    v_exp_f32 v134, v134
    v_pk_mul_f32 v[92:93], v[92:93], v[222:223] op_sel_hi:[1,0]
    v_exp_f32 v135, v135
    v_pk_mul_f32 v[94:95], v[94:95], v[222:223] op_sel_hi:[1,0]
    v_exp_f32 v136, v136
    v_pk_mul_f32 v[96:97], v[96:97], v[222:223] op_sel_hi:[1,0]
    ds_read_b128 v[196:199], v203 offset:24576
    s_waitcnt lgkmcnt(5)
    v_mfma_f32_32x32x16_bf16 v[144:159], v[176:179], v[40:43], v[144:159]
    v_exp_f32 v137, v137
    v_pk_mul_f32 v[98:99], v[98:99], v[222:223] op_sel_hi:[1,0]
    v_exp_f32 v138, v138
    v_pk_mul_f32 v[100:101], v[100:101], v[222:223] op_sel_hi:[1,0]
    v_exp_f32 v139, v139
    v_pk_mul_f32 v[102:103], v[102:103], v[222:223] op_sel_hi:[1,0]
    v_exp_f32 v140, v140
    ds_read_b128 v[176:179], v204 offset:24576
    s_waitcnt lgkmcnt(5)
    v_mfma_f32_32x32x16_bf16 v[144:159], v[180:183], v[44:47], v[144:159]
    v_pk_mul_f32 v[104:105], v[104:105], v[222:223] op_sel_hi:[1,0]
    v_exp_f32 v141, v141
    v_pk_mul_f32 v[106:107], v[106:107], v[222:223] op_sel_hi:[1,0]
    v_exp_f32 v142, v142
    v_pk_mul_f32 v[108:109], v[108:109], v[222:223] op_sel_hi:[1,0]
    v_exp_f32 v143, v143
    v_pk_mul_f32 v[110:111], v[110:111], v[222:223] op_sel_hi:[1,0]
    ds_read_b128 v[180:183], v205 offset:24576
    s_waitcnt lgkmcnt(5)
    v_mfma_f32_32x32x16_bf16 v[160:175], v[184:187], v[16:19], 0
    v_add_f32 v225, v112, v113
    v_add_f32 v226, v120, v121
    v_add_f32 v227, v128, v129
    v_add_f32 v228, v136, v137
    v_add_f32 v225, v225, v114
    v_add_f32 v226, v226, v122
    ds_read_b128 v[184:187], v206 offset:24576
    s_waitcnt lgkmcnt(5)
    v_mfma_f32_32x32x16_bf16 v[160:175], v[188:191], v[20:23], v[160:175]
    v_add_f32 v227, v227, v130
    v_add_f32 v228, v228, v138
    v_add_f32 v225, v225, v115
    v_add_f32 v226, v226, v123
    v_add_f32 v227, v227, v131
    v_add_f32 v228, v228, v139
    ds_read_b128 v[188:191], v207 offset:24576
    s_waitcnt lgkmcnt(5)
    v_mfma_f32_32x32x16_bf16 v[160:175], v[192:195], v[24:27], v[160:175]
    v_add_f32 v225, v225, v116
    v_add_f32 v226, v226, v124
    v_add_f32 v227, v227, v132
    v_add_f32 v228, v228, v140
    v_add_f32 v225, v225, v117
    v_add_f32 v226, v226, v125
    s_waitcnt lgkmcnt(4)
    v_mfma_f32_32x32x16_bf16 v[160:175], v[196:199], v[28:31], v[160:175]
    v_add_f32 v227, v227, v133
    v_add_f32 v228, v228, v141
    v_add_f32 v225, v225, v118
    v_add_f32 v226, v226, v126
    v_add_f32 v227, v227, v134
    v_add_f32 v228, v228, v142
    s_waitcnt lgkmcnt(3)
    v_mfma_f32_32x32x16_bf16 v[160:175], v[176:179], v[32:35], v[160:175]
    v_add_f32 v225, v225, v119
    v_add_f32 v226, v226, v127
    v_add_f32 v227, v227, v135
    v_add_f32 v228, v228, v143
    v_add_f32 v225, v225, v226
    v_add_f32 v227, v227, v228
    s_waitcnt lgkmcnt(2)
    v_mfma_f32_32x32x16_bf16 v[160:175], v[180:183], v[36:39], v[160:175]
    v_add_f32 v225, v225, v227
    v_fma_f32 v221, v221, v222, v225
    v_cvt_pk_bf16_f32 v112, v112, v113
    v_cvt_pk_bf16_f32 v113, v114, v115
    v_cvt_pk_bf16_f32 v114, v116, v117
    v_cvt_pk_bf16_f32 v115, v118, v119
    s_waitcnt lgkmcnt(1)
    v_mfma_f32_32x32x16_bf16 v[160:175], v[184:187], v[40:43], v[160:175]
    v_cvt_pk_bf16_f32 v116, v120, v121
    v_cvt_pk_bf16_f32 v117, v122, v123
    v_cvt_pk_bf16_f32 v118, v124, v125
    v_cvt_pk_bf16_f32 v119, v126, v127
    v_cvt_pk_bf16_f32 v120, v128, v129
    v_cvt_pk_bf16_f32 v121, v130, v131
    s_waitcnt lgkmcnt(0)
    v_mfma_f32_32x32x16_bf16 v[160:175], v[188:191], v[44:47], v[160:175]
    v_cvt_pk_bf16_f32 v122, v132, v133
    v_cvt_pk_bf16_f32 v123, v134, v135
    v_cvt_pk_bf16_f32 v124, v136, v137
    v_cvt_pk_bf16_f32 v125, v138, v139
    v_cvt_pk_bf16_f32 v126, v140, v141
    v_cvt_pk_bf16_f32 v127, v142, v143
    v_add_u32 v208, 16384, v208
    v_add_u32 v209, 16384, v209
    v_add_u32 v210, 16384, v210
    v_add_u32 v211, 16384, v211
    v_add_u32 v212, 16384, v212
    v_add_u32 v213, 16384, v213
    v_add_u32 v214, 16384, v214
    v_add_u32 v215, 16384, v215
    s_waitcnt vmcnt(8)
    s_barrier
    s_add_u32 m0, s92, 49152
    s_add_u32 s29, s92, 114688
    buffer_load_dwordx4 v216, s[20:23], s29 offen offset:0 lds
    buffer_load_dwordx4 v217, s[20:23], s29 offen offset:1024 lds
    buffer_load_dwordx4 v218, s[20:23], s29 offen offset:2048 lds
    buffer_load_dwordx4 v219, s[20:23], s29 offen offset:3072 lds
    ds_read_b64_tr_b16 v[176:177], v208 offset:49152
    ds_read_b64_tr_b16 v[178:179], v209 offset:49152
    ds_read_b64_tr_b16 v[180:181], v210 offset:49152
    ds_read_b64_tr_b16 v[182:183], v211 offset:49152
    ds_read_b64_tr_b16 v[184:185], v212 offset:49152
    ds_read_b64_tr_b16 v[186:187], v213 offset:49152
    ds_read_b64_tr_b16 v[188:189], v214 offset:49152
    ds_read_b64_tr_b16 v[190:191], v215 offset:49152
    v_max3_f32 v225, v144, v145, v146
    v_max3_f32 v226, v160, v161, v162
    v_max3_f32 v225, v225, v147, v148
    v_max3_f32 v226, v226, v163, v164
    v_max3_f32 v225, v225, v149, v150
    v_max3_f32 v226, v226, v165, v166
    ds_read_b64_tr_b16 v[192:193], v208 offset:53248
    ds_read_b64_tr_b16 v[194:195], v209 offset:53248
    s_waitcnt lgkmcnt(8)
    v_mfma_f32_32x32x16_bf16 v[48:63], v[176:179], v[112:115], v[48:63]
    v_max3_f32 v225, v225, v151, v152
    v_max3_f32 v226, v226, v167, v168
    v_max3_f32 v225, v225, v153, v154
    v_max3_f32 v226, v226, v169, v170
    ds_read_b64_tr_b16 v[196:197], v210 offset:53248
    ds_read_b64_tr_b16 v[198:199], v211 offset:53248
    s_waitcnt lgkmcnt(8)
    v_mfma_f32_32x32x16_bf16 v[64:79], v[180:183], v[112:115], v[64:79]
    v_max3_f32 v225, v225, v155, v156
    v_max3_f32 v226, v226, v171, v172
    v_max3_f32 v225, v225, v157, v158
    v_max3_f32 v226, v226, v173, v174
    ds_read_b64_tr_b16 v[176:177], v212 offset:53248
    ds_read_b64_tr_b16 v[178:179], v213 offset:53248
    s_waitcnt lgkmcnt(8)
    v_mfma_f32_32x32x16_bf16 v[80:95], v[184:187], v[112:115], v[80:95]
    v_max3_f32 v225, v225, v226, v159
    v_max_f32 v225, v225, v175
    v_mov_b32 v226, v225
    ds_read_b64_tr_b16 v[180:181], v214 offset:53248
    ds_read_b64_tr_b16 v[182:183], v215 offset:53248
    s_waitcnt lgkmcnt(8)
    v_mfma_f32_32x32x16_bf16 v[96:111], v[188:191], v[112:115], v[96:111]
    v_permlane32_swap_b32 v225, v226
    v_max3_f32 v227, v225, v226, v220
    v_sub_f32 v228, v220, v227
    ds_read_b64_tr_b16 v[184:185], v208 offset:57344
    ds_read_b64_tr_b16 v[186:187], v209 offset:57344
    s_waitcnt lgkmcnt(8)
    v_mfma_f32_32x32x16_bf16 v[48:63], v[192:195], v[116:119], v[48:63]
    v_mul_f32 v228, s30, v228
    v_exp_f32 v222, v228
    v_mov_b32 v220, v227
    ds_read_b64_tr_b16 v[188:189], v210 offset:57344
    ds_read_b64_tr_b16 v[190:191], v211 offset:57344
    s_waitcnt lgkmcnt(8)
    v_mfma_f32_32x32x16_bf16 v[64:79], v[196:199], v[116:119], v[64:79]
    v_mul_f32 v224, s30, v220
    v_fma_f32 v144, v144, s30, -v224
    v_fma_f32 v145, v145, s30, -v224
    ds_read_b64_tr_b16 v[192:193], v212 offset:57344
    ds_read_b64_tr_b16 v[194:195], v213 offset:57344
    s_waitcnt lgkmcnt(8)
    v_mfma_f32_32x32x16_bf16 v[80:95], v[176:179], v[116:119], v[80:95]
    v_fma_f32 v146, v146, s30, -v224
    v_fma_f32 v147, v147, s30, -v224
    v_fma_f32 v148, v148, s30, -v224
    ds_read_b64_tr_b16 v[196:197], v214 offset:57344
    ds_read_b64_tr_b16 v[198:199], v215 offset:57344
    s_waitcnt lgkmcnt(8)
    v_mfma_f32_32x32x16_bf16 v[96:111], v[180:183], v[116:119], v[96:111]
    v_fma_f32 v149, v149, s30, -v224
    v_fma_f32 v150, v150, s30, -v224
    v_fma_f32 v151, v151, s30, -v224
    ds_read_b64_tr_b16 v[176:177], v208 offset:61440
    ds_read_b64_tr_b16 v[178:179], v209 offset:61440
    s_waitcnt lgkmcnt(8)
    v_mfma_f32_32x32x16_bf16 v[48:63], v[184:187], v[120:123], v[48:63]
    v_fma_f32 v152, v152, s30, -v224
    v_fma_f32 v153, v153, s30, -v224
    v_fma_f32 v154, v154, s30, -v224
    ds_read_b64_tr_b16 v[180:181], v210 offset:61440
    ds_read_b64_tr_b16 v[182:183], v211 offset:61440
    s_waitcnt lgkmcnt(8)
    v_mfma_f32_32x32x16_bf16 v[64:79], v[188:191], v[120:123], v[64:79]
    v_fma_f32 v155, v155, s30, -v224
    v_fma_f32 v156, v156, s30, -v224
    v_fma_f32 v157, v157, s30, -v224
    ds_read_b64_tr_b16 v[184:185], v212 offset:61440
    ds_read_b64_tr_b16 v[186:187], v213 offset:61440
    s_waitcnt lgkmcnt(8)
    v_mfma_f32_32x32x16_bf16 v[80:95], v[192:195], v[120:123], v[80:95]
    v_fma_f32 v158, v158, s30, -v224
    v_fma_f32 v159, v159, s30, -v224
    v_fma_f32 v160, v160, s30, -v224
    ds_read_b64_tr_b16 v[188:189], v214 offset:61440
    ds_read_b64_tr_b16 v[190:191], v215 offset:61440
    s_waitcnt lgkmcnt(8)
    v_mfma_f32_32x32x16_bf16 v[96:111], v[196:199], v[120:123], v[96:111]
    v_fma_f32 v161, v161, s30, -v224
    v_fma_f32 v162, v162, s30, -v224
    v_fma_f32 v163, v163, s30, -v224
    s_waitcnt lgkmcnt(6)
    v_mfma_f32_32x32x16_bf16 v[48:63], v[176:179], v[124:127], v[48:63]
    v_fma_f32 v164, v164, s30, -v224
    v_fma_f32 v165, v165, s30, -v224
    v_fma_f32 v166, v166, s30, -v224
    s_waitcnt lgkmcnt(4)
    v_mfma_f32_32x32x16_bf16 v[64:79], v[180:183], v[124:127], v[64:79]
    v_fma_f32 v167, v167, s30, -v224
    v_fma_f32 v168, v168, s30, -v224
    v_fma_f32 v169, v169, s30, -v224
    s_waitcnt lgkmcnt(2)
    v_mfma_f32_32x32x16_bf16 v[80:95], v[184:187], v[124:127], v[80:95]
    v_fma_f32 v170, v170, s30, -v224
    v_fma_f32 v171, v171, s30, -v224
    v_fma_f32 v172, v172, s30, -v224
    s_waitcnt lgkmcnt(0)
    v_mfma_f32_32x32x16_bf16 v[96:111], v[188:191], v[124:127], v[96:111]
    v_fma_f32 v173, v173, s30, -v224
    v_fma_f32 v174, v174, s30, -v224
    v_fma_f32 v175, v175, s30, -v224
    s_waitcnt vmcnt(8)
    s_barrier
    s_add_u32 m0, s92, 16384
    s_add_u32 s29, s92, 98304
    buffer_load_dwordx4 v216, s[96:99], s29 offen offset:0 lds
    buffer_load_dwordx4 v217, s[96:99], s29 offen offset:1024 lds
    buffer_load_dwordx4 v218, s[96:99], s29 offen offset:2048 lds
    buffer_load_dwordx4 v219, s[96:99], s29 offen offset:3072 lds
    ds_read_b128 v[176:179], v200 offset:32768
    ds_read_b128 v[180:183], v201 offset:32768
    ds_read_b128 v[184:187], v202 offset:32768
    ds_read_b128 v[188:191], v203 offset:32768
    ds_read_b128 v[192:195], v204 offset:32768
    v_exp_f32 v144, v144
    v_pk_mul_f32 v[48:49], v[48:49], v[222:223] op_sel_hi:[1,0]
    v_exp_f32 v145, v145
    v_pk_mul_f32 v[50:51], v[50:51], v[222:223] op_sel_hi:[1,0]
    v_exp_f32 v146, v146
    v_pk_mul_f32 v[52:53], v[52:53], v[222:223] op_sel_hi:[1,0]
    v_exp_f32 v147, v147
    v_pk_mul_f32 v[54:55], v[54:55], v[222:223] op_sel_hi:[1,0]
    ds_read_b128 v[196:199], v205 offset:32768
    s_waitcnt lgkmcnt(5)
    v_mfma_f32_32x32x16_bf16 v[112:127], v[176:179], v[16:19], 0
    v_exp_f32 v148, v148
    v_pk_mul_f32 v[56:57], v[56:57], v[222:223] op_sel_hi:[1,0]
    v_exp_f32 v149, v149
    v_pk_mul_f32 v[58:59], v[58:59], v[222:223] op_sel_hi:[1,0]
    v_exp_f32 v150, v150
    v_pk_mul_f32 v[60:61], v[60:61], v[222:223] op_sel_hi:[1,0]
    v_exp_f32 v151, v151
    ds_read_b128 v[176:179], v206 offset:32768
    s_waitcnt lgkmcnt(5)
    v_mfma_f32_32x32x16_bf16 v[112:127], v[180:183], v[20:23], v[112:127]
    v_pk_mul_f32 v[62:63], v[62:63], v[222:223] op_sel_hi:[1,0]
    v_exp_f32 v152, v152
    v_pk_mul_f32 v[64:65], v[64:65], v[222:223] op_sel_hi:[1,0]
    v_exp_f32 v153, v153
    v_pk_mul_f32 v[66:67], v[66:67], v[222:223] op_sel_hi:[1,0]
    v_exp_f32 v154, v154
    v_pk_mul_f32 v[68:69], v[68:69], v[222:223] op_sel_hi:[1,0]
    ds_read_b128 v[180:183], v207 offset:32768
    s_waitcnt lgkmcnt(5)
    v_mfma_f32_32x32x16_bf16 v[112:127], v[184:187], v[24:27], v[112:127]
    v_exp_f32 v155, v155
    v_pk_mul_f32 v[70:71], v[70:71], v[222:223] op_sel_hi:[1,0]
    v_exp_f32 v156, v156
    v_pk_mul_f32 v[72:73], v[72:73], v[222:223] op_sel_hi:[1,0]
    v_exp_f32 v157, v157
    v_pk_mul_f32 v[74:75], v[74:75], v[222:223] op_sel_hi:[1,0]
    v_exp_f32 v158, v158
    ds_read_b128 v[184:187], v200 offset:40960
    s_waitcnt lgkmcnt(5)
    v_mfma_f32_32x32x16_bf16 v[112:127], v[188:191], v[28:31], v[112:127]
    v_pk_mul_f32 v[76:77], v[76:77], v[222:223] op_sel_hi:[1,0]
    v_exp_f32 v159, v159
    v_pk_mul_f32 v[78:79], v[78:79], v[222:223] op_sel_hi:[1,0]
    v_exp_f32 v160, v160
    v_pk_mul_f32 v[80:81], v[80:81], v[222:223] op_sel_hi:[1,0]
    v_exp_f32 v161, v161
    v_pk_mul_f32 v[82:83], v[82:83], v[222:223] op_sel_hi:[1,0]
    ds_read_b128 v[188:191], v201 offset:40960
    s_waitcnt lgkmcnt(5)
    v_mfma_f32_32x32x16_bf16 v[112:127], v[192:195], v[32:35], v[112:127]
    v_exp_f32 v162, v162
    v_pk_mul_f32 v[84:85], v[84:85], v[222:223] op_sel_hi:[1,0]
    v_exp_f32 v163, v163
    v_pk_mul_f32 v[86:87], v[86:87], v[222:223] op_sel_hi:[1,0]
    v_exp_f32 v164, v164
    v_pk_mul_f32 v[88:89], v[88:89], v[222:223] op_sel_hi:[1,0]
    v_exp_f32 v165, v165
    ds_read_b128 v[192:195], v202 offset:40960
    s_waitcnt lgkmcnt(5)
    v_mfma_f32_32x32x16_bf16 v[112:127], v[196:199], v[36:39], v[112:127]
    v_pk_mul_f32 v[90:91], v[90:91], v[222:223] op_sel_hi:[1,0]
    v_exp_f32 v166, v166
    v_pk_mul_f32 v[92:93], v[92:93], v[222:223] op_sel_hi:[1,0]
    v_exp_f32 v167, v167
    v_pk_mul_f32 v[94:95], v[94:95], v[222:223] op_sel_hi:[1,0]
    v_exp_f32 v168, v168
    v_pk_mul_f32 v[96:97], v[96:97], v[222:223] op_sel_hi:[1,0]
    ds_read_b128 v[196:199], v203 offset:40960
    s_waitcnt lgkmcnt(5)
    v_mfma_f32_32x32x16_bf16 v[112:127], v[176:179], v[40:43], v[112:127]
    v_exp_f32 v169, v169
    v_pk_mul_f32 v[98:99], v[98:99], v[222:223] op_sel_hi:[1,0]
    v_exp_f32 v170, v170
    v_pk_mul_f32 v[100:101], v[100:101], v[222:223] op_sel_hi:[1,0]
    v_exp_f32 v171, v171
    v_pk_mul_f32 v[102:103], v[102:103], v[222:223] op_sel_hi:[1,0]
    v_exp_f32 v172, v172
    ds_read_b128 v[176:179], v204 offset:40960
    s_waitcnt lgkmcnt(5)
    v_mfma_f32_32x32x16_bf16 v[112:127], v[180:183], v[44:47], v[112:127]
    v_pk_mul_f32 v[104:105], v[104:105], v[222:223] op_sel_hi:[1,0]
    v_exp_f32 v173, v173
    v_pk_mul_f32 v[106:107], v[106:107], v[222:223] op_sel_hi:[1,0]
    v_exp_f32 v174, v174
    v_pk_mul_f32 v[108:109], v[108:109], v[222:223] op_sel_hi:[1,0]
    v_exp_f32 v175, v175
    v_pk_mul_f32 v[110:111], v[110:111], v[222:223] op_sel_hi:[1,0]
    ds_read_b128 v[180:183], v205 offset:40960
    s_waitcnt lgkmcnt(5)
    v_mfma_f32_32x32x16_bf16 v[128:143], v[184:187], v[16:19], 0
    v_add_f32 v225, v144, v145
    v_add_f32 v226, v152, v153
    v_add_f32 v227, v160, v161
    v_add_f32 v228, v168, v169
    v_add_f32 v225, v225, v146
    v_add_f32 v226, v226, v154
    ds_read_b128 v[184:187], v206 offset:40960
    s_waitcnt lgkmcnt(5)
    v_mfma_f32_32x32x16_bf16 v[128:143], v[188:191], v[20:23], v[128:143]
    v_add_f32 v227, v227, v162
    v_add_f32 v228, v228, v170
    v_add_f32 v225, v225, v147
    v_add_f32 v226, v226, v155
    v_add_f32 v227, v227, v163
    v_add_f32 v228, v228, v171
    ds_read_b128 v[188:191], v207 offset:40960
    s_waitcnt lgkmcnt(5)
    v_mfma_f32_32x32x16_bf16 v[128:143], v[192:195], v[24:27], v[128:143]
    v_add_f32 v225, v225, v148
    v_add_f32 v226, v226, v156
    v_add_f32 v227, v227, v164
    v_add_f32 v228, v228, v172
    v_add_f32 v225, v225, v149
    v_add_f32 v226, v226, v157
    s_waitcnt lgkmcnt(4)
    v_mfma_f32_32x32x16_bf16 v[128:143], v[196:199], v[28:31], v[128:143]
    v_add_f32 v227, v227, v165
    v_add_f32 v228, v228, v173
    v_add_f32 v225, v225, v150
    v_add_f32 v226, v226, v158
    v_add_f32 v227, v227, v166
    v_add_f32 v228, v228, v174
    s_waitcnt lgkmcnt(3)
    v_mfma_f32_32x32x16_bf16 v[128:143], v[176:179], v[32:35], v[128:143]
    v_add_f32 v225, v225, v151
    v_add_f32 v226, v226, v159
    v_add_f32 v227, v227, v167
    v_add_f32 v228, v228, v175
    v_add_f32 v225, v225, v226
    v_add_f32 v227, v227, v228
    s_waitcnt lgkmcnt(2)
    v_mfma_f32_32x32x16_bf16 v[128:143], v[180:183], v[36:39], v[128:143]
    v_add_f32 v225, v225, v227
    v_fma_f32 v221, v221, v222, v225
    v_cvt_pk_bf16_f32 v144, v144, v145
    v_cvt_pk_bf16_f32 v145, v146, v147
    v_cvt_pk_bf16_f32 v146, v148, v149
    v_cvt_pk_bf16_f32 v147, v150, v151
    s_waitcnt lgkmcnt(1)
    v_mfma_f32_32x32x16_bf16 v[128:143], v[184:187], v[40:43], v[128:143]
    v_cvt_pk_bf16_f32 v148, v152, v153
    v_cvt_pk_bf16_f32 v149, v154, v155
    v_cvt_pk_bf16_f32 v150, v156, v157
    v_cvt_pk_bf16_f32 v151, v158, v159
    v_cvt_pk_bf16_f32 v152, v160, v161
    v_cvt_pk_bf16_f32 v153, v162, v163
    s_waitcnt lgkmcnt(0)
    v_mfma_f32_32x32x16_bf16 v[128:143], v[188:191], v[44:47], v[128:143]
    v_cvt_pk_bf16_f32 v154, v164, v165
    v_cvt_pk_bf16_f32 v155, v166, v167
    v_cvt_pk_bf16_f32 v156, v168, v169
    v_cvt_pk_bf16_f32 v157, v170, v171
    v_cvt_pk_bf16_f32 v158, v172, v173
    v_cvt_pk_bf16_f32 v159, v174, v175
    v_subrev_u32 v208, 16384, v208
    v_subrev_u32 v209, 16384, v209
    v_subrev_u32 v210, 16384, v210
    v_subrev_u32 v211, 16384, v211
    v_subrev_u32 v212, 16384, v212
    v_subrev_u32 v213, 16384, v213
    v_subrev_u32 v214, 16384, v214
    v_subrev_u32 v215, 16384, v215
    s_waitcnt vmcnt(8)
    s_barrier
    s_add_u32 m0, s92, 65536
    s_add_u32 s29, s92, 114688
    buffer_load_dwordx4 v216, s[96:99], s29 offen offset:0 lds
    buffer_load_dwordx4 v217, s[96:99], s29 offen offset:1024 lds
    buffer_load_dwordx4 v218, s[96:99], s29 offen offset:2048 lds
    buffer_load_dwordx4 v219, s[96:99], s29 offen offset:3072 lds
    ds_read_b64_tr_b16 v[176:177], v208 offset:0
    ds_read_b64_tr_b16 v[178:179], v209 offset:0
    ds_read_b64_tr_b16 v[180:181], v210 offset:0
    ds_read_b64_tr_b16 v[182:183], v211 offset:0
    ds_read_b64_tr_b16 v[184:185], v212 offset:0
    ds_read_b64_tr_b16 v[186:187], v213 offset:0
    ds_read_b64_tr_b16 v[188:189], v214 offset:0
    ds_read_b64_tr_b16 v[190:191], v215 offset:0
    v_max3_f32 v225, v112, v113, v114
    v_max3_f32 v226, v128, v129, v130
    v_max3_f32 v225, v225, v115, v116
    v_max3_f32 v226, v226, v131, v132
    v_max3_f32 v225, v225, v117, v118
    v_max3_f32 v226, v226, v133, v134
    ds_read_b64_tr_b16 v[192:193], v208 offset:4096
    ds_read_b64_tr_b16 v[194:195], v209 offset:4096
    s_waitcnt lgkmcnt(8)
    v_mfma_f32_32x32x16_bf16 v[48:63], v[176:179], v[144:147], v[48:63]
    v_max3_f32 v225, v225, v119, v120
    v_max3_f32 v226, v226, v135, v136
    v_max3_f32 v225, v225, v121, v122
    v_max3_f32 v226, v226, v137, v138
    ds_read_b64_tr_b16 v[196:197], v210 offset:4096
    ds_read_b64_tr_b16 v[198:199], v211 offset:4096
    s_waitcnt lgkmcnt(8)
    v_mfma_f32_32x32x16_bf16 v[64:79], v[180:183], v[144:147], v[64:79]
    v_max3_f32 v225, v225, v123, v124
    v_max3_f32 v226, v226, v139, v140
    v_max3_f32 v225, v225, v125, v126
    v_max3_f32 v226, v226, v141, v142
    ds_read_b64_tr_b16 v[176:177], v212 offset:4096
    ds_read_b64_tr_b16 v[178:179], v213 offset:4096
    s_waitcnt lgkmcnt(8)
    v_mfma_f32_32x32x16_bf16 v[80:95], v[184:187], v[144:147], v[80:95]
    v_max3_f32 v225, v225, v226, v127
    v_max_f32 v225, v225, v143
    v_mov_b32 v226, v225
    ds_read_b64_tr_b16 v[180:181], v214 offset:4096
    ds_read_b64_tr_b16 v[182:183], v215 offset:4096
    s_waitcnt lgkmcnt(8)
    v_mfma_f32_32x32x16_bf16 v[96:111], v[188:191], v[144:147], v[96:111]
    v_permlane32_swap_b32 v225, v226
    v_max3_f32 v227, v225, v226, v220
    v_sub_f32 v228, v220, v227
    ds_read_b64_tr_b16 v[184:185], v208 offset:8192
    ds_read_b64_tr_b16 v[186:187], v209 offset:8192
    s_waitcnt lgkmcnt(8)
    v_mfma_f32_32x32x16_bf16 v[48:63], v[192:195], v[148:151], v[48:63]
    v_mul_f32 v228, s30, v228
    v_exp_f32 v222, v228
    v_mov_b32 v220, v227
    ds_read_b64_tr_b16 v[188:189], v210 offset:8192
    ds_read_b64_tr_b16 v[190:191], v211 offset:8192
    s_waitcnt lgkmcnt(8)
    v_mfma_f32_32x32x16_bf16 v[64:79], v[196:199], v[148:151], v[64:79]
    v_mul_f32 v224, s30, v220
    v_fma_f32 v112, v112, s30, -v224
    v_fma_f32 v113, v113, s30, -v224
    ds_read_b64_tr_b16 v[192:193], v212 offset:8192
    ds_read_b64_tr_b16 v[194:195], v213 offset:8192
    s_waitcnt lgkmcnt(8)
    v_mfma_f32_32x32x16_bf16 v[80:95], v[176:179], v[148:151], v[80:95]
    v_fma_f32 v114, v114, s30, -v224
    v_fma_f32 v115, v115, s30, -v224
    v_fma_f32 v116, v116, s30, -v224
    ds_read_b64_tr_b16 v[196:197], v214 offset:8192
    ds_read_b64_tr_b16 v[198:199], v215 offset:8192
    s_waitcnt lgkmcnt(8)
    v_mfma_f32_32x32x16_bf16 v[96:111], v[180:183], v[148:151], v[96:111]
    v_fma_f32 v117, v117, s30, -v224
    v_fma_f32 v118, v118, s30, -v224
    v_fma_f32 v119, v119, s30, -v224
    ds_read_b64_tr_b16 v[176:177], v208 offset:12288
    ds_read_b64_tr_b16 v[178:179], v209 offset:12288
    s_waitcnt lgkmcnt(8)
    v_mfma_f32_32x32x16_bf16 v[48:63], v[184:187], v[152:155], v[48:63]
    v_fma_f32 v120, v120, s30, -v224
    v_fma_f32 v121, v121, s30, -v224
    v_fma_f32 v122, v122, s30, -v224
    ds_read_b64_tr_b16 v[180:181], v210 offset:12288
    ds_read_b64_tr_b16 v[182:183], v211 offset:12288
    s_waitcnt lgkmcnt(8)
    v_mfma_f32_32x32x16_bf16 v[64:79], v[188:191], v[152:155], v[64:79]
    v_fma_f32 v123, v123, s30, -v224
    v_fma_f32 v124, v124, s30, -v224
    v_fma_f32 v125, v125, s30, -v224
    ds_read_b64_tr_b16 v[184:185], v212 offset:12288
    ds_read_b64_tr_b16 v[186:187], v213 offset:12288
    s_waitcnt lgkmcnt(8)
    v_mfma_f32_32x32x16_bf16 v[80:95], v[192:195], v[152:155], v[80:95]
    v_fma_f32 v126, v126, s30, -v224
    v_fma_f32 v127, v127, s30, -v224
    v_fma_f32 v128, v128, s30, -v224
    ds_read_b64_tr_b16 v[188:189], v214 offset:12288
    ds_read_b64_tr_b16 v[190:191], v215 offset:12288
    s_waitcnt lgkmcnt(8)
    v_mfma_f32_32x32x16_bf16 v[96:111], v[196:199], v[152:155], v[96:111]
    v_fma_f32 v129, v129, s30, -v224
    v_fma_f32 v130, v130, s30, -v224
    v_fma_f32 v131, v131, s30, -v224
    s_waitcnt lgkmcnt(6)
    v_mfma_f32_32x32x16_bf16 v[48:63], v[176:179], v[156:159], v[48:63]
    v_fma_f32 v132, v132, s30, -v224
    v_fma_f32 v133, v133, s30, -v224
    v_fma_f32 v134, v134, s30, -v224
    s_waitcnt lgkmcnt(4)
    v_mfma_f32_32x32x16_bf16 v[64:79], v[180:183], v[156:159], v[64:79]
    v_fma_f32 v135, v135, s30, -v224
    v_fma_f32 v136, v136, s30, -v224
    v_fma_f32 v137, v137, s30, -v224
    s_waitcnt lgkmcnt(2)
    v_mfma_f32_32x32x16_bf16 v[80:95], v[184:187], v[156:159], v[80:95]
    v_fma_f32 v138, v138, s30, -v224
    v_fma_f32 v139, v139, s30, -v224
    v_fma_f32 v140, v140, s30, -v224
    s_waitcnt lgkmcnt(0)
    v_mfma_f32_32x32x16_bf16 v[96:111], v[188:191], v[156:159], v[96:111]
    v_fma_f32 v141, v141, s30, -v224
    v_fma_f32 v142, v142, s30, -v224
    v_fma_f32 v143, v143, s30, -v224
    s_waitcnt vmcnt(8)
    s_barrier
    ds_read_b128 v[176:179], v200 offset:49152
    ds_read_b128 v[180:183], v201 offset:49152
    ds_read_b128 v[184:187], v202 offset:49152
    ds_read_b128 v[188:191], v203 offset:49152
    ds_read_b128 v[192:195], v204 offset:49152
    v_exp_f32 v112, v112
    v_pk_mul_f32 v[48:49], v[48:49], v[222:223] op_sel_hi:[1,0]
    v_exp_f32 v113, v113
    v_pk_mul_f32 v[50:51], v[50:51], v[222:223] op_sel_hi:[1,0]
    v_exp_f32 v114, v114
    v_pk_mul_f32 v[52:53], v[52:53], v[222:223] op_sel_hi:[1,0]
    v_exp_f32 v115, v115
    v_pk_mul_f32 v[54:55], v[54:55], v[222:223] op_sel_hi:[1,0]
    ds_read_b128 v[196:199], v205 offset:49152
    s_waitcnt lgkmcnt(5)
    v_mfma_f32_32x32x16_bf16 v[144:159], v[176:179], v[16:19], 0
    v_exp_f32 v116, v116
    v_pk_mul_f32 v[56:57], v[56:57], v[222:223] op_sel_hi:[1,0]
    v_exp_f32 v117, v117
    v_pk_mul_f32 v[58:59], v[58:59], v[222:223] op_sel_hi:[1,0]
    v_exp_f32 v118, v118
    v_pk_mul_f32 v[60:61], v[60:61], v[222:223] op_sel_hi:[1,0]
    v_exp_f32 v119, v119
    ds_read_b128 v[176:179], v206 offset:49152
    s_waitcnt lgkmcnt(5)
    v_mfma_f32_32x32x16_bf16 v[144:159], v[180:183], v[20:23], v[144:159]
    v_pk_mul_f32 v[62:63], v[62:63], v[222:223] op_sel_hi:[1,0]
    v_exp_f32 v120, v120
    v_pk_mul_f32 v[64:65], v[64:65], v[222:223] op_sel_hi:[1,0]
    v_exp_f32 v121, v121
    v_pk_mul_f32 v[66:67], v[66:67], v[222:223] op_sel_hi:[1,0]
    v_exp_f32 v122, v122
    v_pk_mul_f32 v[68:69], v[68:69], v[222:223] op_sel_hi:[1,0]
    ds_read_b128 v[180:183], v207 offset:49152
    s_waitcnt lgkmcnt(5)
    v_mfma_f32_32x32x16_bf16 v[144:159], v[184:187], v[24:27], v[144:159]
    v_exp_f32 v123, v123
    v_pk_mul_f32 v[70:71], v[70:71], v[222:223] op_sel_hi:[1,0]
    v_exp_f32 v124, v124
    v_pk_mul_f32 v[72:73], v[72:73], v[222:223] op_sel_hi:[1,0]
    v_exp_f32 v125, v125
    v_pk_mul_f32 v[74:75], v[74:75], v[222:223] op_sel_hi:[1,0]
    v_exp_f32 v126, v126
    ds_read_b128 v[184:187], v200 offset:57344
    s_waitcnt lgkmcnt(5)
    v_mfma_f32_32x32x16_bf16 v[144:159], v[188:191], v[28:31], v[144:159]
    v_pk_mul_f32 v[76:77], v[76:77], v[222:223] op_sel_hi:[1,0]
    v_exp_f32 v127, v127
    v_pk_mul_f32 v[78:79], v[78:79], v[222:223] op_sel_hi:[1,0]
    v_exp_f32 v128, v128
    v_pk_mul_f32 v[80:81], v[80:81], v[222:223] op_sel_hi:[1,0]
    v_exp_f32 v129, v129
    v_pk_mul_f32 v[82:83], v[82:83], v[222:223] op_sel_hi:[1,0]
    ds_read_b128 v[188:191], v201 offset:57344
    s_waitcnt lgkmcnt(5)
    v_mfma_f32_32x32x16_bf16 v[144:159], v[192:195], v[32:35], v[144:159]
    v_exp_f32 v130, v130
    v_pk_mul_f32 v[84:85], v[84:85], v[222:223] op_sel_hi:[1,0]
    v_exp_f32 v131, v131
    v_pk_mul_f32 v[86:87], v[86:87], v[222:223] op_sel_hi:[1,0]
    v_exp_f32 v132, v132
    v_pk_mul_f32 v[88:89], v[88:89], v[222:223] op_sel_hi:[1,0]
    v_exp_f32 v133, v133
    ds_read_b128 v[192:195], v202 offset:57344
    s_waitcnt lgkmcnt(5)
    v_mfma_f32_32x32x16_bf16 v[144:159], v[196:199], v[36:39], v[144:159]
    v_pk_mul_f32 v[90:91], v[90:91], v[222:223] op_sel_hi:[1,0]
    v_exp_f32 v134, v134
    v_pk_mul_f32 v[92:93], v[92:93], v[222:223] op_sel_hi:[1,0]
    v_exp_f32 v135, v135
    v_pk_mul_f32 v[94:95], v[94:95], v[222:223] op_sel_hi:[1,0]
    v_exp_f32 v136, v136
    v_pk_mul_f32 v[96:97], v[96:97], v[222:223] op_sel_hi:[1,0]
    ds_read_b128 v[196:199], v203 offset:57344
    s_waitcnt lgkmcnt(5)
    v_mfma_f32_32x32x16_bf16 v[144:159], v[176:179], v[40:43], v[144:159]
    v_exp_f32 v137, v137
    v_pk_mul_f32 v[98:99], v[98:99], v[222:223] op_sel_hi:[1,0]
    v_exp_f32 v138, v138
    v_pk_mul_f32 v[100:101], v[100:101], v[222:223] op_sel_hi:[1,0]
    v_exp_f32 v139, v139
    v_pk_mul_f32 v[102:103], v[102:103], v[222:223] op_sel_hi:[1,0]
    v_exp_f32 v140, v140
    ds_read_b128 v[176:179], v204 offset:57344
    s_waitcnt lgkmcnt(5)
    v_mfma_f32_32x32x16_bf16 v[144:159], v[180:183], v[44:47], v[144:159]
    v_pk_mul_f32 v[104:105], v[104:105], v[222:223] op_sel_hi:[1,0]
    v_exp_f32 v141, v141
    v_pk_mul_f32 v[106:107], v[106:107], v[222:223] op_sel_hi:[1,0]
    v_exp_f32 v142, v142
    v_pk_mul_f32 v[108:109], v[108:109], v[222:223] op_sel_hi:[1,0]
    v_exp_f32 v143, v143
    v_pk_mul_f32 v[110:111], v[110:111], v[222:223] op_sel_hi:[1,0]
    ds_read_b128 v[180:183], v205 offset:57344
    s_waitcnt lgkmcnt(5)
    v_mfma_f32_32x32x16_bf16 v[160:175], v[184:187], v[16:19], 0
    v_add_f32 v225, v112, v113
    v_add_f32 v226, v120, v121
    v_add_f32 v227, v128, v129
    v_add_f32 v228, v136, v137
    v_add_f32 v225, v225, v114
    v_add_f32 v226, v226, v122
    ds_read_b128 v[184:187], v206 offset:57344
    s_waitcnt lgkmcnt(5)
    v_mfma_f32_32x32x16_bf16 v[160:175], v[188:191], v[20:23], v[160:175]
    v_add_f32 v227, v227, v130
    v_add_f32 v228, v228, v138
    v_add_f32 v225, v225, v115
    v_add_f32 v226, v226, v123
    v_add_f32 v227, v227, v131
    v_add_f32 v228, v228, v139
    ds_read_b128 v[188:191], v207 offset:57344
    s_waitcnt lgkmcnt(5)
    v_mfma_f32_32x32x16_bf16 v[160:175], v[192:195], v[24:27], v[160:175]
    v_add_f32 v225, v225, v116
    v_add_f32 v226, v226, v124
    v_add_f32 v227, v227, v132
    v_add_f32 v228, v228, v140
    v_add_f32 v225, v225, v117
    v_add_f32 v226, v226, v125
    s_waitcnt lgkmcnt(4)
    v_mfma_f32_32x32x16_bf16 v[160:175], v[196:199], v[28:31], v[160:175]
    v_add_f32 v227, v227, v133
    v_add_f32 v228, v228, v141
    v_add_f32 v225, v225, v118
    v_add_f32 v226, v226, v126
    v_add_f32 v227, v227, v134
    v_add_f32 v228, v228, v142
    s_waitcnt lgkmcnt(3)
    v_mfma_f32_32x32x16_bf16 v[160:175], v[176:179], v[32:35], v[160:175]
    v_add_f32 v225, v225, v119
    v_add_f32 v226, v226, v127
    v_add_f32 v227, v227, v135
    v_add_f32 v228, v228, v143
    v_add_f32 v225, v225, v226
    v_add_f32 v227, v227, v228
    s_waitcnt lgkmcnt(2)
    v_mfma_f32_32x32x16_bf16 v[160:175], v[180:183], v[36:39], v[160:175]
    v_add_f32 v225, v225, v227
    v_fma_f32 v221, v221, v222, v225
    v_cvt_pk_bf16_f32 v112, v112, v113
    v_cvt_pk_bf16_f32 v113, v114, v115
    v_cvt_pk_bf16_f32 v114, v116, v117
    v_cvt_pk_bf16_f32 v115, v118, v119
    s_waitcnt lgkmcnt(1)
    v_mfma_f32_32x32x16_bf16 v[160:175], v[184:187], v[40:43], v[160:175]
    v_cvt_pk_bf16_f32 v116, v120, v121
    v_cvt_pk_bf16_f32 v117, v122, v123
    v_cvt_pk_bf16_f32 v118, v124, v125
    v_cvt_pk_bf16_f32 v119, v126, v127
    v_cvt_pk_bf16_f32 v120, v128, v129
    v_cvt_pk_bf16_f32 v121, v130, v131
    s_waitcnt lgkmcnt(0)
    v_mfma_f32_32x32x16_bf16 v[160:175], v[188:191], v[44:47], v[160:175]
    v_cvt_pk_bf16_f32 v122, v132, v133
    v_cvt_pk_bf16_f32 v123, v134, v135
    v_cvt_pk_bf16_f32 v124, v136, v137
    v_cvt_pk_bf16_f32 v125, v138, v139
    v_cvt_pk_bf16_f32 v126, v140, v141
    v_cvt_pk_bf16_f32 v127, v142, v143
    s_waitcnt vmcnt(4)
    s_barrier
    ds_read_b64_tr_b16 v[176:177], v208 offset:16384
    ds_read_b64_tr_b16 v[178:179], v209 offset:16384
    ds_read_b64_tr_b16 v[180:181], v210 offset:16384
    ds_read_b64_tr_b16 v[182:183], v211 offset:16384
    ds_read_b64_tr_b16 v[184:185], v212 offset:16384
    ds_read_b64_tr_b16 v[186:187], v213 offset:16384
    ds_read_b64_tr_b16 v[188:189], v214 offset:16384
    ds_read_b64_tr_b16 v[190:191], v215 offset:16384
    v_max3_f32 v225, v144, v145, v146
    v_max3_f32 v226, v160, v161, v162
    v_max3_f32 v225, v225, v147, v148
    v_max3_f32 v226, v226, v163, v164
    v_max3_f32 v225, v225, v149, v150
    v_max3_f32 v226, v226, v165, v166
    ds_read_b64_tr_b16 v[192:193], v208 offset:20480
    ds_read_b64_tr_b16 v[194:195], v209 offset:20480
    s_waitcnt lgkmcnt(8)
    v_mfma_f32_32x32x16_bf16 v[48:63], v[176:179], v[112:115], v[48:63]
    v_max3_f32 v225, v225, v151, v152
    v_max3_f32 v226, v226, v167, v168
    v_max3_f32 v225, v225, v153, v154
    v_max3_f32 v226, v226, v169, v170
    ds_read_b64_tr_b16 v[196:197], v210 offset:20480
    ds_read_b64_tr_b16 v[198:199], v211 offset:20480
    s_waitcnt lgkmcnt(8)
    v_mfma_f32_32x32x16_bf16 v[64:79], v[180:183], v[112:115], v[64:79]
    v_max3_f32 v225, v225, v155, v156
    v_max3_f32 v226, v226, v171, v172
    v_max3_f32 v225, v225, v157, v158
    v_max3_f32 v226, v226, v173, v174
    ds_read_b64_tr_b16 v[176:177], v212 offset:20480
    ds_read_b64_tr_b16 v[178:179], v213 offset:20480
    s_waitcnt lgkmcnt(8)
    v_mfma_f32_32x32x16_bf16 v[80:95], v[184:187], v[112:115], v[80:95]
    v_max3_f32 v225, v225, v226, v159
    v_max_f32 v225, v225, v175
    v_mov_b32 v226, v225
    ds_read_b64_tr_b16 v[180:181], v214 offset:20480
    ds_read_b64_tr_b16 v[182:183], v215 offset:20480
    s_waitcnt lgkmcnt(8)
    v_mfma_f32_32x32x16_bf16 v[96:111], v[188:191], v[112:115], v[96:111]
    v_permlane32_swap_b32 v225, v226
    v_max3_f32 v227, v225, v226, v220
    v_sub_f32 v228, v220, v227
    ds_read_b64_tr_b16 v[184:185], v208 offset:24576
    ds_read_b64_tr_b16 v[186:187], v209 offset:24576
    s_waitcnt lgkmcnt(8)
    v_mfma_f32_32x32x16_bf16 v[48:63], v[192:195], v[116:119], v[48:63]
    v_mul_f32 v228, s30, v228
    v_exp_f32 v222, v228
    v_mov_b32 v220, v227
    ds_read_b64_tr_b16 v[188:189], v210 offset:24576
    ds_read_b64_tr_b16 v[190:191], v211 offset:24576
    s_waitcnt lgkmcnt(8)
    v_mfma_f32_32x32x16_bf16 v[64:79], v[196:199], v[116:119], v[64:79]
    v_mul_f32 v224, s30, v220
    v_fma_f32 v144, v144, s30, -v224
    v_fma_f32 v145, v145, s30, -v224
    ds_read_b64_tr_b16 v[192:193], v212 offset:24576
    ds_read_b64_tr_b16 v[194:195], v213 offset:24576
    s_waitcnt lgkmcnt(8)
    v_mfma_f32_32x32x16_bf16 v[80:95], v[176:179], v[116:119], v[80:95]
    v_fma_f32 v146, v146, s30, -v224
    v_fma_f32 v147, v147, s30, -v224
    v_fma_f32 v148, v148, s30, -v224
    ds_read_b64_tr_b16 v[196:197], v214 offset:24576
    ds_read_b64_tr_b16 v[198:199], v215 offset:24576
    s_waitcnt lgkmcnt(8)
    v_mfma_f32_32x32x16_bf16 v[96:111], v[180:183], v[116:119], v[96:111]
    v_fma_f32 v149, v149, s30, -v224
    v_fma_f32 v150, v150, s30, -v224
    v_fma_f32 v151, v151, s30, -v224
    ds_read_b64_tr_b16 v[176:177], v208 offset:28672
    ds_read_b64_tr_b16 v[178:179], v209 offset:28672
    s_waitcnt lgkmcnt(8)
    v_mfma_f32_32x32x16_bf16 v[48:63], v[184:187], v[120:123], v[48:63]
    v_fma_f32 v152, v152, s30, -v224
    v_fma_f32 v153, v153, s30, -v224
    v_fma_f32 v154, v154, s30, -v224
    ds_read_b64_tr_b16 v[180:181], v210 offset:28672
    ds_read_b64_tr_b16 v[182:183], v211 offset:28672
    s_waitcnt lgkmcnt(8)
    v_mfma_f32_32x32x16_bf16 v[64:79], v[188:191], v[120:123], v[64:79]
    v_fma_f32 v155, v155, s30, -v224
    v_fma_f32 v156, v156, s30, -v224
    v_fma_f32 v157, v157, s30, -v224
    ds_read_b64_tr_b16 v[184:185], v212 offset:28672
    ds_read_b64_tr_b16 v[186:187], v213 offset:28672
    s_waitcnt lgkmcnt(8)
    v_mfma_f32_32x32x16_bf16 v[80:95], v[192:195], v[120:123], v[80:95]
    v_fma_f32 v158, v158, s30, -v224
    v_fma_f32 v159, v159, s30, -v224
    v_fma_f32 v160, v160, s30, -v224
    ds_read_b64_tr_b16 v[188:189], v214 offset:28672
    ds_read_b64_tr_b16 v[190:191], v215 offset:28672
    s_waitcnt lgkmcnt(8)
    v_mfma_f32_32x32x16_bf16 v[96:111], v[196:199], v[120:123], v[96:111]
    v_fma_f32 v161, v161, s30, -v224
    v_fma_f32 v162, v162, s30, -v224
    v_fma_f32 v163, v163, s30, -v224
    s_waitcnt lgkmcnt(6)
    v_mfma_f32_32x32x16_bf16 v[48:63], v[176:179], v[124:127], v[48:63]
    v_fma_f32 v164, v164, s30, -v224
    v_fma_f32 v165, v165, s30, -v224
    v_fma_f32 v166, v166, s30, -v224
    s_waitcnt lgkmcnt(4)
    v_mfma_f32_32x32x16_bf16 v[64:79], v[180:183], v[124:127], v[64:79]
    v_fma_f32 v167, v167, s30, -v224
    v_fma_f32 v168, v168, s30, -v224
    v_fma_f32 v169, v169, s30, -v224
    s_waitcnt lgkmcnt(2)
    v_mfma_f32_32x32x16_bf16 v[80:95], v[184:187], v[124:127], v[80:95]
    v_fma_f32 v170, v170, s30, -v224
    v_fma_f32 v171, v171, s30, -v224
    v_fma_f32 v172, v172, s30, -v224
    s_waitcnt lgkmcnt(0)
    v_mfma_f32_32x32x16_bf16 v[96:111], v[188:191], v[124:127], v[96:111]
    v_fma_f32 v173, v173, s30, -v224
    v_fma_f32 v174, v174, s30, -v224
    v_fma_f32 v175, v175, s30, -v224
    v_add_u32 v208, 16384, v208
    v_add_u32 v209, 16384, v209
    v_add_u32 v210, 16384, v210
    v_add_u32 v211, 16384, v211
    v_add_u32 v212, 16384, v212
    v_add_u32 v213, 16384, v213
    v_add_u32 v214, 16384, v214
    v_add_u32 v215, 16384, v215
    s_waitcnt vmcnt(0)
    s_barrier
    v_exp_f32 v144, v144
    v_pk_mul_f32 v[48:49], v[48:49], v[222:223] op_sel_hi:[1,0]
    v_exp_f32 v145, v145
    v_pk_mul_f32 v[50:51], v[50:51], v[222:223] op_sel_hi:[1,0]
    v_exp_f32 v146, v146
    v_pk_mul_f32 v[52:53], v[52:53], v[222:223] op_sel_hi:[1,0]
    v_exp_f32 v147, v147
    v_pk_mul_f32 v[54:55], v[54:55], v[222:223] op_sel_hi:[1,0]
    v_exp_f32 v148, v148
    v_pk_mul_f32 v[56:57], v[56:57], v[222:223] op_sel_hi:[1,0]
    v_exp_f32 v149, v149
    v_pk_mul_f32 v[58:59], v[58:59], v[222:223] op_sel_hi:[1,0]
    v_exp_f32 v150, v150
    v_pk_mul_f32 v[60:61], v[60:61], v[222:223] op_sel_hi:[1,0]
    v_exp_f32 v151, v151
    v_pk_mul_f32 v[62:63], v[62:63], v[222:223] op_sel_hi:[1,0]
    v_exp_f32 v152, v152
    v_pk_mul_f32 v[64:65], v[64:65], v[222:223] op_sel_hi:[1,0]
    v_exp_f32 v153, v153
    v_pk_mul_f32 v[66:67], v[66:67], v[222:223] op_sel_hi:[1,0]
    v_exp_f32 v154, v154
    v_pk_mul_f32 v[68:69], v[68:69], v[222:223] op_sel_hi:[1,0]
    v_exp_f32 v155, v155
    v_pk_mul_f32 v[70:71], v[70:71], v[222:223] op_sel_hi:[1,0]
    v_exp_f32 v156, v156
    v_pk_mul_f32 v[72:73], v[72:73], v[222:223] op_sel_hi:[1,0]
    v_exp_f32 v157, v157
    v_pk_mul_f32 v[74:75], v[74:75], v[222:223] op_sel_hi:[1,0]
    v_exp_f32 v158, v158
    v_pk_mul_f32 v[76:77], v[76:77], v[222:223] op_sel_hi:[1,0]
    v_exp_f32 v159, v159
    v_pk_mul_f32 v[78:79], v[78:79], v[222:223] op_sel_hi:[1,0]
    v_exp_f32 v160, v160
    v_pk_mul_f32 v[80:81], v[80:81], v[222:223] op_sel_hi:[1,0]
    v_exp_f32 v161, v161
    v_pk_mul_f32 v[82:83], v[82:83], v[222:223] op_sel_hi:[1,0]
    v_exp_f32 v162, v162
    v_pk_mul_f32 v[84:85], v[84:85], v[222:223] op_sel_hi:[1,0]
    v_exp_f32 v163, v163
    v_pk_mul_f32 v[86:87], v[86:87], v[222:223] op_sel_hi:[1,0]
    v_exp_f32 v164, v164
    v_pk_mul_f32 v[88:89], v[88:89], v[222:223] op_sel_hi:[1,0]
    v_exp_f32 v165, v165
    v_pk_mul_f32 v[90:91], v[90:91], v[222:223] op_sel_hi:[1,0]
    v_exp_f32 v166, v166
    v_pk_mul_f32 v[92:93], v[92:93], v[222:223] op_sel_hi:[1,0]
    v_exp_f32 v167, v167
    v_pk_mul_f32 v[94:95], v[94:95], v[222:223] op_sel_hi:[1,0]
    v_exp_f32 v168, v168
    v_pk_mul_f32 v[96:97], v[96:97], v[222:223] op_sel_hi:[1,0]
    v_exp_f32 v169, v169
    v_pk_mul_f32 v[98:99], v[98:99], v[222:223] op_sel_hi:[1,0]
    v_exp_f32 v170, v170
    v_pk_mul_f32 v[100:101], v[100:101], v[222:223] op_sel_hi:[1,0]
    v_exp_f32 v171, v171
    v_pk_mul_f32 v[102:103], v[102:103], v[222:223] op_sel_hi:[1,0]
    v_exp_f32 v172, v172
    v_pk_mul_f32 v[104:105], v[104:105], v[222:223] op_sel_hi:[1,0]
    v_exp_f32 v173, v173
    v_pk_mul_f32 v[106:107], v[106:107], v[222:223] op_sel_hi:[1,0]
    v_exp_f32 v174, v174
    v_pk_mul_f32 v[108:109], v[108:109], v[222:223] op_sel_hi:[1,0]
    v_exp_f32 v175, v175
    v_pk_mul_f32 v[110:111], v[110:111], v[222:223] op_sel_hi:[1,0]
    v_add_f32 v225, v144, v145
    v_add_f32 v226, v152, v153
    v_add_f32 v227, v160, v161
    v_add_f32 v228, v168, v169
    v_add_f32 v225, v225, v146
    v_add_f32 v226, v226, v154
    v_add_f32 v227, v227, v162
    v_add_f32 v228, v228, v170
    v_add_f32 v225, v225, v147
    v_add_f32 v226, v226, v155
    v_add_f32 v227, v227, v163
    v_add_f32 v228, v228, v171
    v_add_f32 v225, v225, v148
    v_add_f32 v226, v226, v156
    v_add_f32 v227, v227, v164
    v_add_f32 v228, v228, v172
    v_add_f32 v225, v225, v149
    v_add_f32 v226, v226, v157
    v_add_f32 v227, v227, v165
    v_add_f32 v228, v228, v173
    v_add_f32 v225, v225, v150
    v_add_f32 v226, v226, v158
    v_add_f32 v227, v227, v166
    v_add_f32 v228, v228, v174
    v_add_f32 v225, v225, v151
    v_add_f32 v226, v226, v159
    v_add_f32 v227, v227, v167
    v_add_f32 v228, v228, v175
    v_add_f32 v225, v225, v226
    v_add_f32 v227, v227, v228
    v_add_f32 v225, v225, v227
    v_fma_f32 v221, v221, v222, v225
    v_cvt_pk_bf16_f32 v144, v144, v145
    v_cvt_pk_bf16_f32 v145, v146, v147
    v_cvt_pk_bf16_f32 v146, v148, v149
    v_cvt_pk_bf16_f32 v147, v150, v151
    v_cvt_pk_bf16_f32 v148, v152, v153
    v_cvt_pk_bf16_f32 v149, v154, v155
    v_cvt_pk_bf16_f32 v150, v156, v157
    v_cvt_pk_bf16_f32 v151, v158, v159
    v_cvt_pk_bf16_f32 v152, v160, v161
    v_cvt_pk_bf16_f32 v153, v162, v163
    v_cvt_pk_bf16_f32 v154, v164, v165
    v_cvt_pk_bf16_f32 v155, v166, v167
    v_cvt_pk_bf16_f32 v156, v168, v169
    v_cvt_pk_bf16_f32 v157, v170, v171
    v_cvt_pk_bf16_f32 v158, v172, v173
    v_cvt_pk_bf16_f32 v159, v174, v175
    ds_read_b64_tr_b16 v[176:177], v208 offset:49152
    ds_read_b64_tr_b16 v[178:179], v209 offset:49152
    ds_read_b64_tr_b16 v[180:181], v210 offset:49152
    ds_read_b64_tr_b16 v[182:183], v211 offset:49152
    ds_read_b64_tr_b16 v[184:185], v212 offset:49152
    ds_read_b64_tr_b16 v[186:187], v213 offset:49152
    ds_read_b64_tr_b16 v[188:189], v214 offset:49152
    ds_read_b64_tr_b16 v[190:191], v215 offset:49152
    ds_read_b64_tr_b16 v[192:193], v208 offset:53248
    ds_read_b64_tr_b16 v[194:195], v209 offset:53248
    s_waitcnt lgkmcnt(8)
    v_mfma_f32_32x32x16_bf16 v[48:63], v[176:179], v[144:147], v[48:63]
    ds_read_b64_tr_b16 v[196:197], v210 offset:53248
    ds_read_b64_tr_b16 v[198:199], v211 offset:53248
    s_waitcnt lgkmcnt(8)
    v_mfma_f32_32x32x16_bf16 v[64:79], v[180:183], v[144:147], v[64:79]
    ds_read_b64_tr_b16 v[176:177], v212 offset:53248
    ds_read_b64_tr_b16 v[178:179], v213 offset:53248
    s_waitcnt lgkmcnt(8)
    v_mfma_f32_32x32x16_bf16 v[80:95], v[184:187], v[144:147], v[80:95]
    ds_read_b64_tr_b16 v[180:181], v214 offset:53248
    ds_read_b64_tr_b16 v[182:183], v215 offset:53248
    s_waitcnt lgkmcnt(8)
    v_mfma_f32_32x32x16_bf16 v[96:111], v[188:191], v[144:147], v[96:111]
    ds_read_b64_tr_b16 v[184:185], v208 offset:57344
    ds_read_b64_tr_b16 v[186:187], v209 offset:57344
    s_waitcnt lgkmcnt(8)
    v_mfma_f32_32x32x16_bf16 v[48:63], v[192:195], v[148:151], v[48:63]
    ds_read_b64_tr_b16 v[188:189], v210 offset:57344
    ds_read_b64_tr_b16 v[190:191], v211 offset:57344
    s_waitcnt lgkmcnt(8)
    v_mfma_f32_32x32x16_bf16 v[64:79], v[196:199], v[148:151], v[64:79]
    ds_read_b64_tr_b16 v[192:193], v212 offset:57344
    ds_read_b64_tr_b16 v[194:195], v213 offset:57344
    s_waitcnt lgkmcnt(8)
    v_mfma_f32_32x32x16_bf16 v[80:95], v[176:179], v[148:151], v[80:95]
    ds_read_b64_tr_b16 v[196:197], v214 offset:57344
    ds_read_b64_tr_b16 v[198:199], v215 offset:57344
    s_waitcnt lgkmcnt(8)
    v_mfma_f32_32x32x16_bf16 v[96:111], v[180:183], v[148:151], v[96:111]
    ds_read_b64_tr_b16 v[176:177], v208 offset:61440
    ds_read_b64_tr_b16 v[178:179], v209 offset:61440
    s_waitcnt lgkmcnt(8)
    v_mfma_f32_32x32x16_bf16 v[48:63], v[184:187], v[152:155], v[48:63]
    ds_read_b64_tr_b16 v[180:181], v210 offset:61440
    ds_read_b64_tr_b16 v[182:183], v211 offset:61440
    s_waitcnt lgkmcnt(8)
    v_mfma_f32_32x32x16_bf16 v[64:79], v[188:191], v[152:155], v[64:79]
    ds_read_b64_tr_b16 v[184:185], v212 offset:61440
    ds_read_b64_tr_b16 v[186:187], v213 offset:61440
    s_waitcnt lgkmcnt(8)
    v_mfma_f32_32x32x16_bf16 v[80:95], v[192:195], v[152:155], v[80:95]
    ds_read_b64_tr_b16 v[188:189], v214 offset:61440
    ds_read_b64_tr_b16 v[190:191], v215 offset:61440
    s_waitcnt lgkmcnt(8)
    v_mfma_f32_32x32x16_bf16 v[96:111], v[196:199], v[152:155], v[96:111]
    s_waitcnt lgkmcnt(6)
    v_mfma_f32_32x32x16_bf16 v[48:63], v[176:179], v[156:159], v[48:63]
    s_waitcnt lgkmcnt(4)
    v_mfma_f32_32x32x16_bf16 v[64:79], v[180:183], v[156:159], v[64:79]
    s_waitcnt lgkmcnt(2)
    v_mfma_f32_32x32x16_bf16 v[80:95], v[184:187], v[156:159], v[80:95]
    s_waitcnt lgkmcnt(0)
    v_mfma_f32_32x32x16_bf16 v[96:111], v[188:191], v[156:159], v[96:111]
    v_mov_b32 v225, v221
    v_mov_b32 v226, v221
    s_nop 1
    v_permlane32_swap_b32 v225, v226
    v_add_f32 v225, v225, v226
    v_rcp_f32 v222, v225
    s_lshl_b32 s29, s37, 12
    v_pk_mul_f32 v[48:49], v[48:49], v[222:223] op_sel_hi:[1,0]
    v_pk_mul_f32 v[50:51], v[50:51], v[222:223] op_sel_hi:[1,0]
    v_pk_mul_f32 v[52:53], v[52:53], v[222:223] op_sel_hi:[1,0]
    v_pk_mul_f32 v[54:55], v[54:55], v[222:223] op_sel_hi:[1,0]
    v_pk_mul_f32 v[56:57], v[56:57], v[222:223] op_sel_hi:[1,0]
    v_pk_mul_f32 v[58:59], v[58:59], v[222:223] op_sel_hi:[1,0]
    v_pk_mul_f32 v[60:61], v[60:61], v[222:223] op_sel_hi:[1,0]
    v_pk_mul_f32 v[62:63], v[62:63], v[222:223] op_sel_hi:[1,0]
    v_cvt_pk_bf16_f32 v144, v48, v49
    v_cvt_pk_bf16_f32 v145, v50, v51
    v_cvt_pk_bf16_f32 v146, v56, v57
    v_cvt_pk_bf16_f32 v147, v58, v59
    buffer_store_dwordx4 v[144:147], v229, s[4:7], s29 offen offset:0 sc1
    v_cvt_pk_bf16_f32 v148, v52, v53
    v_cvt_pk_bf16_f32 v149, v54, v55
    v_cvt_pk_bf16_f32 v150, v60, v61
    v_cvt_pk_bf16_f32 v151, v62, v63
    buffer_store_dwordx4 v[148:151], v229, s[4:7], s29 offen offset:512 sc1
    v_pk_mul_f32 v[64:65], v[64:65], v[222:223] op_sel_hi:[1,0]
    v_pk_mul_f32 v[66:67], v[66:67], v[222:223] op_sel_hi:[1,0]
    v_pk_mul_f32 v[68:69], v[68:69], v[222:223] op_sel_hi:[1,0]
    v_pk_mul_f32 v[70:71], v[70:71], v[222:223] op_sel_hi:[1,0]
    v_pk_mul_f32 v[72:73], v[72:73], v[222:223] op_sel_hi:[1,0]
    v_pk_mul_f32 v[74:75], v[74:75], v[222:223] op_sel_hi:[1,0]
    v_pk_mul_f32 v[76:77], v[76:77], v[222:223] op_sel_hi:[1,0]
    v_pk_mul_f32 v[78:79], v[78:79], v[222:223] op_sel_hi:[1,0]
    v_cvt_pk_bf16_f32 v152, v64, v65
    v_cvt_pk_bf16_f32 v153, v66, v67
    v_cvt_pk_bf16_f32 v154, v72, v73
    v_cvt_pk_bf16_f32 v155, v74, v75
    buffer_store_dwordx4 v[152:155], v229, s[4:7], s29 offen offset:1024 sc1
    v_cvt_pk_bf16_f32 v156, v68, v69
    v_cvt_pk_bf16_f32 v157, v70, v71
    v_cvt_pk_bf16_f32 v158, v76, v77
    v_cvt_pk_bf16_f32 v159, v78, v79
    buffer_store_dwordx4 v[156:159], v229, s[4:7], s29 offen offset:1536 sc1
    v_pk_mul_f32 v[80:81], v[80:81], v[222:223] op_sel_hi:[1,0]
    v_pk_mul_f32 v[82:83], v[82:83], v[222:223] op_sel_hi:[1,0]
    v_pk_mul_f32 v[84:85], v[84:85], v[222:223] op_sel_hi:[1,0]
    v_pk_mul_f32 v[86:87], v[86:87], v[222:223] op_sel_hi:[1,0]
    v_pk_mul_f32 v[88:89], v[88:89], v[222:223] op_sel_hi:[1,0]
    v_pk_mul_f32 v[90:91], v[90:91], v[222:223] op_sel_hi:[1,0]
    v_pk_mul_f32 v[92:93], v[92:93], v[222:223] op_sel_hi:[1,0]
    v_pk_mul_f32 v[94:95], v[94:95], v[222:223] op_sel_hi:[1,0]
    v_cvt_pk_bf16_f32 v160, v80, v81
    v_cvt_pk_bf16_f32 v161, v82, v83
    v_cvt_pk_bf16_f32 v162, v88, v89
    v_cvt_pk_bf16_f32 v163, v90, v91
    buffer_store_dwordx4 v[160:163], v229, s[4:7], s29 offen offset:2048 sc1
    v_cvt_pk_bf16_f32 v164, v84, v85
    v_cvt_pk_bf16_f32 v165, v86, v87
    v_cvt_pk_bf16_f32 v166, v92, v93
    v_cvt_pk_bf16_f32 v167, v94, v95
    buffer_store_dwordx4 v[164:167], v229, s[4:7], s29 offen offset:2560 sc1
    v_pk_mul_f32 v[96:97], v[96:97], v[222:223] op_sel_hi:[1,0]
    v_pk_mul_f32 v[98:99], v[98:99], v[222:223] op_sel_hi:[1,0]
    v_pk_mul_f32 v[100:101], v[100:101], v[222:223] op_sel_hi:[1,0]
    v_pk_mul_f32 v[102:103], v[102:103], v[222:223] op_sel_hi:[1,0]
    v_pk_mul_f32 v[104:105], v[104:105], v[222:223] op_sel_hi:[1,0]
    v_pk_mul_f32 v[106:107], v[106:107], v[222:223] op_sel_hi:[1,0]
    v_pk_mul_f32 v[108:109], v[108:109], v[222:223] op_sel_hi:[1,0]
    v_pk_mul_f32 v[110:111], v[110:111], v[222:223] op_sel_hi:[1,0]
    v_cvt_pk_bf16_f32 v168, v96, v97
    v_cvt_pk_bf16_f32 v169, v98, v99
    v_cvt_pk_bf16_f32 v170, v104, v105
    v_cvt_pk_bf16_f32 v171, v106, v107
    buffer_store_dwordx4 v[168:171], v229, s[4:7], s29 offen offset:3072 sc1
    v_cvt_pk_bf16_f32 v172, v100, v101
    v_cvt_pk_bf16_f32 v173, v102, v103
    v_cvt_pk_bf16_f32 v174, v108, v109
    v_cvt_pk_bf16_f32 v175, v110, v111
    buffer_store_dwordx4 v[172:175], v229, s[4:7], s29 offen offset:3584 sc1
    s_cmp_ge_u32 s2, 256
    s_cbranch_scc1 PK_2
    s_lshl_b32 s77, s34, 5
    s_add_u32 s77, s77, s32
    s_barrier
    s_mul_i32 s29, s77, 40960
    s_add_u32 s84, s74, s29
    s_addc_u32 s85, s75, 0
    s_and_b32 s85, s85, 0xffff
    s_mov_b32 s86, 40960
    s_mov_b32 s87, 0x00020000
    s_mul_i32 s29, s39, 5242880
    s_add_u32 s8, s72, s29
    s_addc_u32 s9, s73, 0
    s_add_u32 s8, s8, 33554432
    s_addc_u32 s9, s9, 0
    s_and_b32 s9, s9, 0xffff
    s_mov_b32 s10, 5242880
    s_mov_b32 s11, 0x00020000
    v_lshlrev_b32 v17, 4, v1
    v_add_u32 v18, 0x1000, v17
    v_lshl_add_u32 v10, v3, 2, v7
    v_mul_u32_u24 v10, 0x500, v10
    v_lshl_add_u32 v10, v8, 3, v10
    s_mul_i32 s76, s24, 320
    v_add_u32 v16, s76, v10
    s_mul_i32 s76, s24, 10240
    s_add_u32 m0, s76, 0
    s_add_u32 s29, s76, 0
    buffer_load_dwordx4 v17, s[84:87], s29 offen offset:0 lds
    buffer_load_dwordx4 v17, s[84:87], s29 offen offset:1024 lds
    buffer_load_dwordx4 v17, s[84:87], s29 offen offset:2048 lds
    buffer_load_dwordx4 v17, s[84:87], s29 offen offset:3072 lds
    s_add_u32 m0, s76, 4096
    s_add_u32 s29, s76, 4096
    buffer_load_dwordx4 v17, s[84:87], s29 offen offset:0 lds
    buffer_load_dwordx4 v17, s[84:87], s29 offen offset:1024 lds
    buffer_load_dwordx4 v17, s[84:87], s29 offen offset:2048 lds
    buffer_load_dwordx4 v17, s[84:87], s29 offen offset:3072 lds
    s_add_u32 m0, s76, 8192
    s_add_u32 s29, s76, 8192
    buffer_load_dwordx4 v17, s[84:87], s29 offen offset:0 lds
    buffer_load_dwordx4 v17, s[84:87], s29 offen offset:1024 lds
    s_waitcnt vmcnt(0)
    s_barrier
    ds_read_b64_tr_b16 v[48:49], v16 offset:0
    ds_read_b64_tr_b16 v[50:51], v16 offset:20480
    ds_read_b64_tr_b16 v[52:53], v16 offset:32
    ds_read_b64_tr_b16 v[54:55], v16 offset:20512
    ds_read_b64_tr_b16 v[56:57], v16 offset:64
    ds_read_b64_tr_b16 v[58:59], v16 offset:20544
    ds_read_b64_tr_b16 v[60:61], v16 offset:96
    ds_read_b64_tr_b16 v[62:63], v16 offset:20576
    ds_read_b64_tr_b16 v[64:65], v16 offset:128
    ds_read_b64_tr_b16 v[66:67], v16 offset:20608
    s_waitcnt lgkmcnt(0)
    s_lshl_b32 s29, s24, 1
    s_add_u32 s29, s29, 0
    s_lshl_b32 s29, s29, 7
    s_add_u32 s29, s29, s77
    s_mul_i32 s29, s29, 5120
    buffer_store_dwordx4 v[48:51], v17, s[8:11], s29 offen offset:0 sc1
    buffer_store_dwordx4 v[52:55], v17, s[8:11], s29 offen offset:1024 sc1
    buffer_store_dwordx4 v[56:59], v17, s[8:11], s29 offen offset:2048 sc1
    buffer_store_dwordx4 v[60:63], v17, s[8:11], s29 offen offset:3072 sc1
    buffer_store_dwordx4 v[64:67], v18, s[8:11], s29 offen sc1
    ds_read_b64_tr_b16 v[68:69], v16 offset:160
    ds_read_b64_tr_b16 v[70:71], v16 offset:20640
    ds_read_b64_tr_b16 v[72:73], v16 offset:192
    ds_read_b64_tr_b16 v[74:75], v16 offset:20672
    ds_read_b64_tr_b16 v[76:77], v16 offset:224
    ds_read_b64_tr_b16 v[78:79], v16 offset:20704
    ds_read_b64_tr_b16 v[80:81], v16 offset:256
    ds_read_b64_tr_b16 v[82:83], v16 offset:20736
    ds_read_b64_tr_b16 v[84:85], v16 offset:288
    ds_read_b64_tr_b16 v[86:87], v16 offset:20768
    s_waitcnt lgkmcnt(0)
    s_lshl_b32 s29, s24, 1
    s_add_u32 s29, s29, 1
    s_lshl_b32 s29, s29, 7
    s_add_u32 s29, s29, s77
    s_mul_i32 s29, s29, 5120
    buffer_store_dwordx4 v[68:71], v17, s[8:11], s29 offen offset:0 sc1
    buffer_store_dwordx4 v[72:75], v17, s[8:11], s29 offen offset:1024 sc1
    buffer_store_dwordx4 v[76:79], v17, s[8:11], s29 offen offset:2048 sc1
    buffer_store_dwordx4 v[80:83], v17, s[8:11], s29 offen offset:3072 sc1
    buffer_store_dwordx4 v[84:87], v18, s[8:11], s29 offen sc1
PK_2:
    s_nop 3
attn_done:
    s_endpgm
.globl oproj_kernel
.p2align 8
.type oproj_kernel,@function
oproj_kernel:
    s_cmp_ge_u32 s2, 256
    s_cbranch_scc1 oproj_done
    s_load_dwordx16 s[48:63], s[0:1], 0
    s_load_dwordx8 s[64:71], s[0:1], 64
    s_load_dwordx2 s[72:73], s[0:1], 96
    s_and_b32 s31, s2, 7
    s_lshr_b32 s32, s2, 3
    s_lshr_b32 s33, s31, 2
    s_bfe_u32 s34, s31, 0x10001
    s_and_b32 s35, s31, 1
    s_and_b32 s36, s32, 7
    s_lshl_b32 s34, s34, 3
    s_add_u32 s34, s34, s36
    s_lshr_b32 s36, s32, 3
    s_lshl_b32 s35, s35, 2
    s_add_u32 s35, s35, s36
    s_lshl_b32 s38, s33, 3
    s_add_u32 s38, s38, s35
    v_and_b32 v1, 63, v0
    v_lshrrev_b32 v2, 6, v0
    s_nop 0
    v_readfirstlane_b32 s24, v2
    v_lshrrev_b32 v3, 4, v1
    v_and_b32 v4, 15, v1
    v_lshrrev_b32 v5, 5, v1
    v_and_b32 v6, 31, v1
    v_bfe_u32 v7, v1, 2, 2
    v_and_b32 v8, 3, v1
    v_and_b32 v9, 1, v3
    v_mov_b32 v15, 0
    v_lshlrev_b32 v246, 4, v1
    v_add_u32 v247, 0x1000, v246
    v_add_u32 v248, 0, v246
    v_add_u32 v249, 131072, v246
    v_add_u32 v250, 262144, v246
    v_add_u32 v251, 393216, v246
    s_waitcnt lgkmcnt(0)
    s_mul_i32 s29, s38, 655360
    s_add_u32 s12, s72, s29
    s_addc_u32 s13, s73, 0
    s_add_u32 s12, s12, 33554432
    s_addc_u32 s13, s13, 0
    s_and_b32 s13, s13, 0xffff
    s_mov_b32 s14, 655360
    s_mov_b32 s15, 0x00020000
    s_lshl_b32 s29, s33, 4
    s_add_u32 s29, s29, s34
    s_lshl_b32 s29, s29, 19
    s_add_u32 s16, s72, s29
    s_addc_u32 s17, s73, 0
    s_and_b32 s17, s17, 0xffff
    s_mov_b32 s18, 524288
    s_mov_b32 s19, 0x00020000
    s_lshl_b32 s26, s24, 4
    s_mul_i32 s27, s26, 5120
    s_lshl_b32 s28, s26, 10
    s_add_u32 s29, s27, 0
    s_add_u32 s30, s28, 0
    buffer_load_dwordx4 v[96:99], v246, s[12:15], s29 offen offset:0
    buffer_load_dwordx4 v[100:103], v246, s[12:15], s29 offen offset:1024
    buffer_load_dwordx4 v[104:107], v246, s[12:15], s29 offen offset:2048
    buffer_load_dwordx4 v[108:111], v246, s[12:15], s29 offen offset:3072
    buffer_load_dwordx4 v[112:115], v247, s[12:15], s29 offen
    buffer_load_dwordx4 v[116:119], v248, s[16:19], s30 offen
    buffer_load_dwordx4 v[120:123], v249, s[16:19], s30 offen
    buffer_load_dwordx4 v[124:127], v250, s[16:19], s30 offen
    buffer_load_dwordx4 v[128:131], v251, s[16:19], s30 offen
    s_add_u32 s29, s27, 5120
    s_add_u32 s30, s28, 1024
    buffer_load_dwordx4 v[132:135], v246, s[12:15], s29 offen offset:0
    buffer_load_dwordx4 v[136:139], v246, s[12:15], s29 offen offset:1024
    buffer_load_dwordx4 v[140:143], v246, s[12:15], s29 offen offset:2048
    buffer_load_dwordx4 v[144:147], v246, s[12:15], s29 offen offset:3072
    buffer_load_dwordx4 v[148:151], v247, s[12:15], s29 offen
    buffer_load_dwordx4 v[152:155], v248, s[16:19], s30 offen
    buffer_load_dwordx4 v[156:159], v249, s[16:19], s30 offen
    buffer_load_dwordx4 v[160:163], v250, s[16:19], s30 offen
    buffer_load_dwordx4 v[164:167], v251, s[16:19], s30 offen
    s_add_u32 s29, s27, 10240
    s_add_u32 s30, s28, 2048
    buffer_load_dwordx4 v[168:171], v246, s[12:15], s29 offen offset:0
    buffer_load_dwordx4 v[172:175], v246, s[12:15], s29 offen offset:1024
    buffer_load_dwordx4 v[176:179], v246, s[12:15], s29 offen offset:2048
    buffer_load_dwordx4 v[180:183], v246, s[12:15], s29 offen offset:3072
    buffer_load_dwordx4 v[184:187], v247, s[12:15], s29 offen
    buffer_load_dwordx4 v[188:191], v248, s[16:19], s30 offen
    buffer_load_dwordx4 v[192:195], v249, s[16:19], s30 offen
    buffer_load_dwordx4 v[196:199], v250, s[16:19], s30 offen
    buffer_load_dwordx4 v[200:203], v251, s[16:19], s30 offen
    s_add_u32 s29, s27, 15360
    s_add_u32 s30, s28, 3072
    buffer_load_dwordx4 v[204:207], v246, s[12:15], s29 offen offset:0
    buffer_load_dwordx4 v[208:211], v246, s[12:15], s29 offen offset:1024
    buffer_load_dwordx4 v[212:215], v246, s[12:15], s29 offen offset:2048
    buffer_load_dwordx4 v[216:219], v246, s[12:15], s29 offen offset:3072
    buffer_load_dwordx4 v[220:223], v247, s[12:15], s29 offen
    buffer_load_dwordx4 v[224:227], v248, s[16:19], s30 offen
    buffer_load_dwordx4 v[228:231], v249, s[16:19], s30 offen
    buffer_load_dwordx4 v[232:235], v250, s[16:19], s30 offen
    buffer_load_dwordx4 v[236:239], v251, s[16:19], s30 offen
    s_mul_i32 s29, s34, 163840
    s_mul_i32 s30, s33, 1280
    s_add_u32 s29, s29, s30
    s_mul_i32 s30, s35, 160
    s_add_u32 s29, s29, s30
    s_sub_u32 s30, 2621440, s29
    s_add_u32 s20, s68, s29
    s_addc_u32 s21, s69, 0
    s_and_b32 s21, s21, 0xffff
    s_mov_b32 s22, s30
    s_mov_b32 s23, 0x00020000
    s_waitcnt vmcnt(27)
    v_mfma_f32_16x16x32_bf16 v[16:19], v[96:99], v[116:119], 0
    v_mfma_f32_16x16x32_bf16 v[20:23], v[96:99], v[120:123], 0
    v_mfma_f32_16x16x32_bf16 v[24:27], v[96:99], v[124:127], 0
    v_mfma_f32_16x16x32_bf16 v[28:31], v[96:99], v[128:131], 0
    v_mfma_f32_16x16x32_bf16 v[32:35], v[100:103], v[116:119], 0
    v_mfma_f32_16x16x32_bf16 v[36:39], v[100:103], v[120:123], 0
    v_mfma_f32_16x16x32_bf16 v[40:43], v[100:103], v[124:127], 0
    v_mfma_f32_16x16x32_bf16 v[44:47], v[100:103], v[128:131], 0
    v_mfma_f32_16x16x32_bf16 v[48:51], v[104:107], v[116:119], 0
    v_mfma_f32_16x16x32_bf16 v[52:55], v[104:107], v[120:123], 0
    v_mfma_f32_16x16x32_bf16 v[56:59], v[104:107], v[124:127], 0
    v_mfma_f32_16x16x32_bf16 v[60:63], v[104:107], v[128:131], 0
    v_mfma_f32_16x16x32_bf16 v[64:67], v[108:111], v[116:119], 0
    v_mfma_f32_16x16x32_bf16 v[68:71], v[108:111], v[120:123], 0
    v_mfma_f32_16x16x32_bf16 v[72:75], v[108:111], v[124:127], 0
    v_mfma_f32_16x16x32_bf16 v[76:79], v[108:111], v[128:131], 0
    v_mfma_f32_16x16x32_bf16 v[80:83], v[112:115], v[116:119], 0
    v_mfma_f32_16x16x32_bf16 v[84:87], v[112:115], v[120:123], 0
    v_mfma_f32_16x16x32_bf16 v[88:91], v[112:115], v[124:127], 0
    v_mfma_f32_16x16x32_bf16 v[92:95], v[112:115], v[128:131], 0
    s_add_u32 s29, s27, 20480
    s_add_u32 s30, s28, 4096
    buffer_load_dwordx4 v[96:99], v246, s[12:15], s29 offen offset:0
    buffer_load_dwordx4 v[100:103], v246, s[12:15], s29 offen offset:1024
    buffer_load_dwordx4 v[104:107], v246, s[12:15], s29 offen offset:2048
    buffer_load_dwordx4 v[108:111], v246, s[12:15], s29 offen offset:3072
    buffer_load_dwordx4 v[112:115], v247, s[12:15], s29 offen
    buffer_load_dwordx4 v[116:119], v248, s[16:19], s30 offen
    buffer_load_dwordx4 v[120:123], v249, s[16:19], s30 offen
    buffer_load_dwordx4 v[124:127], v250, s[16:19], s30 offen
    buffer_load_dwordx4 v[128:131], v251, s[16:19], s30 offen
    s_waitcnt vmcnt(27)
    v_mfma_f32_16x16x32_bf16 v[16:19], v[132:135], v[152:155], v[16:19]
    v_mfma_f32_16x16x32_bf16 v[20:23], v[132:135], v[156:159], v[20:23]
    v_mfma_f32_16x16x32_bf16 v[24:27], v[132:135], v[160:163], v[24:27]
    v_mfma_f32_16x16x32_bf16 v[28:31], v[132:135], v[164:167], v[28:31]
    v_mfma_f32_16x16x32_bf16 v[32:35], v[136:139], v[152:155], v[32:35]
    v_mfma_f32_16x16x32_bf16 v[36:39], v[136:139], v[156:159], v[36:39]
    v_mfma_f32_16x16x32_bf16 v[40:43], v[136:139], v[160:163], v[40:43]
    v_mfma_f32_16x16x32_bf16 v[44:47], v[136:139], v[164:167], v[44:47]
    v_mfma_f32_16x16x32_bf16 v[48:51], v[140:143], v[152:155], v[48:51]
    v_mfma_f32_16x16x32_bf16 v[52:55], v[140:143], v[156:159], v[52:55]
    v_mfma_f32_16x16x32_bf16 v[56:59], v[140:143], v[160:163], v[56:59]
    v_mfma_f32_16x16x32_bf16 v[60:63], v[140:143], v[164:167], v[60:63]
    v_mfma_f32_16x16x32_bf16 v[64:67], v[144:147], v[152:155], v[64:67]
    v_mfma_f32_16x16x32_bf16 v[68:71], v[144:147], v[156:159], v[68:71]
    v_mfma_f32_16x16x32_bf16 v[72:75], v[144:147], v[160:163], v[72:75]
    v_mfma_f32_16x16x32_bf16 v[76:79], v[144:147], v[164:167], v[76:79]
    v_mfma_f32_16x16x32_bf16 v[80:83], v[148:151], v[152:155], v[80:83]
    v_mfma_f32_16x16x32_bf16 v[84:87], v[148:151], v[156:159], v[84:87]
    v_mfma_f32_16x16x32_bf16 v[88:91], v[148:151], v[160:163], v[88:91]
    v_mfma_f32_16x16x32_bf16 v[92:95], v[148:151], v[164:167], v[92:95]
    s_add_u32 s29, s27, 25600
    s_add_u32 s30, s28, 5120
    buffer_load_dwordx4 v[132:135], v246, s[12:15], s29 offen offset:0
    buffer_load_dwordx4 v[136:139], v246, s[12:15], s29 offen offset:1024
    buffer_load_dwordx4 v[140:143], v246, s[12:15], s29 offen offset:2048
    buffer_load_dwordx4 v[144:147], v246, s[12:15], s29 offen offset:3072
    buffer_load_dwordx4 v[148:151], v247, s[12:15], s29 offen
    buffer_load_dwordx4 v[152:155], v248, s[16:19], s30 offen
    buffer_load_dwordx4 v[156:159], v249, s[16:19], s30 offen
    buffer_load_dwordx4 v[160:163], v250, s[16:19], s30 offen
    buffer_load_dwordx4 v[164:167], v251, s[16:19], s30 offen
    s_waitcnt vmcnt(27)
    v_mfma_f32_16x16x32_bf16 v[16:19], v[168:171], v[188:191], v[16:19]
    v_mfma_f32_16x16x32_bf16 v[20:23], v[168:171], v[192:195], v[20:23]
    v_mfma_f32_16x16x32_bf16 v[24:27], v[168:171], v[196:199], v[24:27]
    v_mfma_f32_16x16x32_bf16 v[28:31], v[168:171], v[200:203], v[28:31]
    v_mfma_f32_16x16x32_bf16 v[32:35], v[172:175], v[188:191], v[32:35]
    v_mfma_f32_16x16x32_bf16 v[36:39], v[172:175], v[192:195], v[36:39]
    v_mfma_f32_16x16x32_bf16 v[40:43], v[172:175], v[196:199], v[40:43]
    v_mfma_f32_16x16x32_bf16 v[44:47], v[172:175], v[200:203], v[44:47]
    v_mfma_f32_16x16x32_bf16 v[48:51], v[176:179], v[188:191], v[48:51]
    v_mfma_f32_16x16x32_bf16 v[52:55], v[176:179], v[192:195], v[52:55]
    v_mfma_f32_16x16x32_bf16 v[56:59], v[176:179], v[196:199], v[56:59]
    v_mfma_f32_16x16x32_bf16 v[60:63], v[176:179], v[200:203], v[60:63]
    v_mfma_f32_16x16x32_bf16 v[64:67], v[180:183], v[188:191], v[64:67]
    v_mfma_f32_16x16x32_bf16 v[68:71], v[180:183], v[192:195], v[68:71]
    v_mfma_f32_16x16x32_bf16 v[72:75], v[180:183], v[196:199], v[72:75]
    v_mfma_f32_16x16x32_bf16 v[76:79], v[180:183], v[200:203], v[76:79]
    v_mfma_f32_16x16x32_bf16 v[80:83], v[184:187], v[188:191], v[80:83]
    v_mfma_f32_16x16x32_bf16 v[84:87], v[184:187], v[192:195], v[84:87]
    v_mfma_f32_16x16x32_bf16 v[88:91], v[184:187], v[196:199], v[88:91]
    v_mfma_f32_16x16x32_bf16 v[92:95], v[184:187], v[200:203], v[92:95]
    s_add_u32 s29, s27, 30720
    s_add_u32 s30, s28, 6144
    buffer_load_dwordx4 v[168:171], v246, s[12:15], s29 offen offset:0
    buffer_load_dwordx4 v[172:175], v246, s[12:15], s29 offen offset:1024
    buffer_load_dwordx4 v[176:179], v246, s[12:15], s29 offen offset:2048
    buffer_load_dwordx4 v[180:183], v246, s[12:15], s29 offen offset:3072
    buffer_load_dwordx4 v[184:187], v247, s[12:15], s29 offen
    buffer_load_dwordx4 v[188:191], v248, s[16:19], s30 offen
    buffer_load_dwordx4 v[192:195], v249, s[16:19], s30 offen
    buffer_load_dwordx4 v[196:199], v250, s[16:19], s30 offen
    buffer_load_dwordx4 v[200:203], v251, s[16:19], s30 offen
    s_waitcnt vmcnt(27)
    v_mfma_f32_16x16x32_bf16 v[16:19], v[204:207], v[224:227], v[16:19]
    v_mfma_f32_16x16x32_bf16 v[20:23], v[204:207], v[228:231], v[20:23]
    v_mfma_f32_16x16x32_bf16 v[24:27], v[204:207], v[232:235], v[24:27]
    v_mfma_f32_16x16x32_bf16 v[28:31], v[204:207], v[236:239], v[28:31]
    v_mfma_f32_16x16x32_bf16 v[32:35], v[208:211], v[224:227], v[32:35]
    v_mfma_f32_16x16x32_bf16 v[36:39], v[208:211], v[228:231], v[36:39]
    v_mfma_f32_16x16x32_bf16 v[40:43], v[208:211], v[232:235], v[40:43]
    v_mfma_f32_16x16x32_bf16 v[44:47], v[208:211], v[236:239], v[44:47]
    v_mfma_f32_16x16x32_bf16 v[48:51], v[212:215], v[224:227], v[48:51]
    v_mfma_f32_16x16x32_bf16 v[52:55], v[212:215], v[228:231], v[52:55]
    v_mfma_f32_16x16x32_bf16 v[56:59], v[212:215], v[232:235], v[56:59]
    v_mfma_f32_16x16x32_bf16 v[60:63], v[212:215], v[236:239], v[60:63]
    v_mfma_f32_16x16x32_bf16 v[64:67], v[216:219], v[224:227], v[64:67]
    v_mfma_f32_16x16x32_bf16 v[68:71], v[216:219], v[228:231], v[68:71]
    v_mfma_f32_16x16x32_bf16 v[72:75], v[216:219], v[232:235], v[72:75]
    v_mfma_f32_16x16x32_bf16 v[76:79], v[216:219], v[236:239], v[76:79]
    v_mfma_f32_16x16x32_bf16 v[80:83], v[220:223], v[224:227], v[80:83]
    v_mfma_f32_16x16x32_bf16 v[84:87], v[220:223], v[228:231], v[84:87]
    v_mfma_f32_16x16x32_bf16 v[88:91], v[220:223], v[232:235], v[88:91]
    v_mfma_f32_16x16x32_bf16 v[92:95], v[220:223], v[236:239], v[92:95]
    s_add_u32 s29, s27, 35840
    s_add_u32 s30, s28, 7168
    buffer_load_dwordx4 v[204:207], v246, s[12:15], s29 offen offset:0
    buffer_load_dwordx4 v[208:211], v246, s[12:15], s29 offen offset:1024
    buffer_load_dwordx4 v[212:215], v246, s[12:15], s29 offen offset:2048
    buffer_load_dwordx4 v[216:219], v246, s[12:15], s29 offen offset:3072
    buffer_load_dwordx4 v[220:223], v247, s[12:15], s29 offen
    buffer_load_dwordx4 v[224:227], v248, s[16:19], s30 offen
    buffer_load_dwordx4 v[228:231], v249, s[16:19], s30 offen
    buffer_load_dwordx4 v[232:235], v250, s[16:19], s30 offen
    buffer_load_dwordx4 v[236:239], v251, s[16:19], s30 offen
    s_waitcnt vmcnt(27)
    v_mfma_f32_16x16x32_bf16 v[16:19], v[96:99], v[116:119], v[16:19]
    v_mfma_f32_16x16x32_bf16 v[20:23], v[96:99], v[120:123], v[20:23]
    v_mfma_f32_16x16x32_bf16 v[24:27], v[96:99], v[124:127], v[24:27]
    v_mfma_f32_16x16x32_bf16 v[28:31], v[96:99], v[128:131], v[28:31]
    v_mfma_f32_16x16x32_bf16 v[32:35], v[100:103], v[116:119], v[32:35]
    v_mfma_f32_16x16x32_bf16 v[36:39], v[100:103], v[120:123], v[36:39]
    v_mfma_f32_16x16x32_bf16 v[40:43], v[100:103], v[124:127], v[40:43]
    v_mfma_f32_16x16x32_bf16 v[44:47], v[100:103], v[128:131], v[44:47]
    v_mfma_f32_16x16x32_bf16 v[48:51], v[104:107], v[116:119], v[48:51]
    v_mfma_f32_16x16x32_bf16 v[52:55], v[104:107], v[120:123], v[52:55]
    v_mfma_f32_16x16x32_bf16 v[56:59], v[104:107], v[124:127], v[56:59]
    v_mfma_f32_16x16x32_bf16 v[60:63], v[104:107], v[128:131], v[60:63]
    v_mfma_f32_16x16x32_bf16 v[64:67], v[108:111], v[116:119], v[64:67]
    v_mfma_f32_16x16x32_bf16 v[68:71], v[108:111], v[120:123], v[68:71]
    v_mfma_f32_16x16x32_bf16 v[72:75], v[108:111], v[124:127], v[72:75]
    v_mfma_f32_16x16x32_bf16 v[76:79], v[108:111], v[128:131], v[76:79]
    v_mfma_f32_16x16x32_bf16 v[80:83], v[112:115], v[116:119], v[80:83]
    v_mfma_f32_16x16x32_bf16 v[84:87], v[112:115], v[120:123], v[84:87]
    v_mfma_f32_16x16x32_bf16 v[88:91], v[112:115], v[124:127], v[88:91]
    v_mfma_f32_16x16x32_bf16 v[92:95], v[112:115], v[128:131], v[92:95]
    s_add_u32 s29, s27, 40960
    s_add_u32 s30, s28, 8192
    buffer_load_dwordx4 v[96:99], v246, s[12:15], s29 offen offset:0
    buffer_load_dwordx4 v[100:103], v246, s[12:15], s29 offen offset:1024
    buffer_load_dwordx4 v[104:107], v246, s[12:15], s29 offen offset:2048
    buffer_load_dwordx4 v[108:111], v246, s[12:15], s29 offen offset:3072
    buffer_load_dwordx4 v[112:115], v247, s[12:15], s29 offen
    buffer_load_dwordx4 v[116:119], v248, s[16:19], s30 offen
    buffer_load_dwordx4 v[120:123], v249, s[16:19], s30 offen
    buffer_load_dwordx4 v[124:127], v250, s[16:19], s30 offen
    buffer_load_dwordx4 v[128:131], v251, s[16:19], s30 offen
    s_waitcnt vmcnt(27)
    v_mfma_f32_16x16x32_bf16 v[16:19], v[132:135], v[152:155], v[16:19]
    v_mfma_f32_16x16x32_bf16 v[20:23], v[132:135], v[156:159], v[20:23]
    v_mfma_f32_16x16x32_bf16 v[24:27], v[132:135], v[160:163], v[24:27]
    v_mfma_f32_16x16x32_bf16 v[28:31], v[132:135], v[164:167], v[28:31]
    v_mfma_f32_16x16x32_bf16 v[32:35], v[136:139], v[152:155], v[32:35]
    v_mfma_f32_16x16x32_bf16 v[36:39], v[136:139], v[156:159], v[36:39]
    v_mfma_f32_16x16x32_bf16 v[40:43], v[136:139], v[160:163], v[40:43]
    v_mfma_f32_16x16x32_bf16 v[44:47], v[136:139], v[164:167], v[44:47]
    v_mfma_f32_16x16x32_bf16 v[48:51], v[140:143], v[152:155], v[48:51]
    v_mfma_f32_16x16x32_bf16 v[52:55], v[140:143], v[156:159], v[52:55]
    v_mfma_f32_16x16x32_bf16 v[56:59], v[140:143], v[160:163], v[56:59]
    v_mfma_f32_16x16x32_bf16 v[60:63], v[140:143], v[164:167], v[60:63]
    v_mfma_f32_16x16x32_bf16 v[64:67], v[144:147], v[152:155], v[64:67]
    v_mfma_f32_16x16x32_bf16 v[68:71], v[144:147], v[156:159], v[68:71]
    v_mfma_f32_16x16x32_bf16 v[72:75], v[144:147], v[160:163], v[72:75]
    v_mfma_f32_16x16x32_bf16 v[76:79], v[144:147], v[164:167], v[76:79]
    v_mfma_f32_16x16x32_bf16 v[80:83], v[148:151], v[152:155], v[80:83]
    v_mfma_f32_16x16x32_bf16 v[84:87], v[148:151], v[156:159], v[84:87]
    v_mfma_f32_16x16x32_bf16 v[88:91], v[148:151], v[160:163], v[88:91]
    v_mfma_f32_16x16x32_bf16 v[92:95], v[148:151], v[164:167], v[92:95]
    s_add_u32 s29, s27, 46080
    s_add_u32 s30, s28, 9216
    buffer_load_dwordx4 v[132:135], v246, s[12:15], s29 offen offset:0
    buffer_load_dwordx4 v[136:139], v246, s[12:15], s29 offen offset:1024
    buffer_load_dwordx4 v[140:143], v246, s[12:15], s29 offen offset:2048
    buffer_load_dwordx4 v[144:147], v246, s[12:15], s29 offen offset:3072
    buffer_load_dwordx4 v[148:151], v247, s[12:15], s29 offen
    buffer_load_dwordx4 v[152:155], v248, s[16:19], s30 offen
    buffer_load_dwordx4 v[156:159], v249, s[16:19], s30 offen
    buffer_load_dwordx4 v[160:163], v250, s[16:19], s30 offen
    buffer_load_dwordx4 v[164:167], v251, s[16:19], s30 offen
    s_waitcnt vmcnt(27)
    v_mfma_f32_16x16x32_bf16 v[16:19], v[168:171], v[188:191], v[16:19]
    v_mfma_f32_16x16x32_bf16 v[20:23], v[168:171], v[192:195], v[20:23]
    v_mfma_f32_16x16x32_bf16 v[24:27], v[168:171], v[196:199], v[24:27]
    v_mfma_f32_16x16x32_bf16 v[28:31], v[168:171], v[200:203], v[28:31]
    v_mfma_f32_16x16x32_bf16 v[32:35], v[172:175], v[188:191], v[32:35]
    v_mfma_f32_16x16x32_bf16 v[36:39], v[172:175], v[192:195], v[36:39]
    v_mfma_f32_16x16x32_bf16 v[40:43], v[172:175], v[196:199], v[40:43]
    v_mfma_f32_16x16x32_bf16 v[44:47], v[172:175], v[200:203], v[44:47]
    v_mfma_f32_16x16x32_bf16 v[48:51], v[176:179], v[188:191], v[48:51]
    v_mfma_f32_16x16x32_bf16 v[52:55], v[176:179], v[192:195], v[52:55]
    v_mfma_f32_16x16x32_bf16 v[56:59], v[176:179], v[196:199], v[56:59]
    v_mfma_f32_16x16x32_bf16 v[60:63], v[176:179], v[200:203], v[60:63]
    v_mfma_f32_16x16x32_bf16 v[64:67], v[180:183], v[188:191], v[64:67]
    v_mfma_f32_16x16x32_bf16 v[68:71], v[180:183], v[192:195], v[68:71]
    v_mfma_f32_16x16x32_bf16 v[72:75], v[180:183], v[196:199], v[72:75]
    v_mfma_f32_16x16x32_bf16 v[76:79], v[180:183], v[200:203], v[76:79]
    v_mfma_f32_16x16x32_bf16 v[80:83], v[184:187], v[188:191], v[80:83]
    v_mfma_f32_16x16x32_bf16 v[84:87], v[184:187], v[192:195], v[84:87]
    v_mfma_f32_16x16x32_bf16 v[88:91], v[184:187], v[196:199], v[88:91]
    v_mfma_f32_16x16x32_bf16 v[92:95], v[184:187], v[200:203], v[92:95]
    s_add_u32 s29, s27, 51200
    s_add_u32 s30, s28, 10240
    buffer_load_dwordx4 v[168:171], v246, s[12:15], s29 offen offset:0
    buffer_load_dwordx4 v[172:175], v246, s[12:15], s29 offen offset:1024
    buffer_load_dwordx4 v[176:179], v246, s[12:15], s29 offen offset:2048
    buffer_load_dwordx4 v[180:183], v246, s[12:15], s29 offen offset:3072
    buffer_load_dwordx4 v[184:187], v247, s[12:15], s29 offen
    buffer_load_dwordx4 v[188:191], v248, s[16:19], s30 offen
    buffer_load_dwordx4 v[192:195], v249, s[16:19], s30 offen
    buffer_load_dwordx4 v[196:199], v250, s[16:19], s30 offen
    buffer_load_dwordx4 v[200:203], v251, s[16:19], s30 offen
    s_waitcnt vmcnt(27)
    v_mfma_f32_16x16x32_bf16 v[16:19], v[204:207], v[224:227], v[16:19]
    v_mfma_f32_16x16x32_bf16 v[20:23], v[204:207], v[228:231], v[20:23]
    v_mfma_f32_16x16x32_bf16 v[24:27], v[204:207], v[232:235], v[24:27]
    v_mfma_f32_16x16x32_bf16 v[28:31], v[204:207], v[236:239], v[28:31]
    v_mfma_f32_16x16x32_bf16 v[32:35], v[208:211], v[224:227], v[32:35]
    v_mfma_f32_16x16x32_bf16 v[36:39], v[208:211], v[228:231], v[36:39]
    v_mfma_f32_16x16x32_bf16 v[40:43], v[208:211], v[232:235], v[40:43]
    v_mfma_f32_16x16x32_bf16 v[44:47], v[208:211], v[236:239], v[44:47]
    v_mfma_f32_16x16x32_bf16 v[48:51], v[212:215], v[224:227], v[48:51]
    v_mfma_f32_16x16x32_bf16 v[52:55], v[212:215], v[228:231], v[52:55]
    v_mfma_f32_16x16x32_bf16 v[56:59], v[212:215], v[232:235], v[56:59]
    v_mfma_f32_16x16x32_bf16 v[60:63], v[212:215], v[236:239], v[60:63]
    v_mfma_f32_16x16x32_bf16 v[64:67], v[216:219], v[224:227], v[64:67]
    v_mfma_f32_16x16x32_bf16 v[68:71], v[216:219], v[228:231], v[68:71]
    v_mfma_f32_16x16x32_bf16 v[72:75], v[216:219], v[232:235], v[72:75]
    v_mfma_f32_16x16x32_bf16 v[76:79], v[216:219], v[236:239], v[76:79]
    v_mfma_f32_16x16x32_bf16 v[80:83], v[220:223], v[224:227], v[80:83]
    v_mfma_f32_16x16x32_bf16 v[84:87], v[220:223], v[228:231], v[84:87]
    v_mfma_f32_16x16x32_bf16 v[88:91], v[220:223], v[232:235], v[88:91]
    v_mfma_f32_16x16x32_bf16 v[92:95], v[220:223], v[236:239], v[92:95]
    s_add_u32 s29, s27, 56320
    s_add_u32 s30, s28, 11264
    buffer_load_dwordx4 v[204:207], v246, s[12:15], s29 offen offset:0
    buffer_load_dwordx4 v[208:211], v246, s[12:15], s29 offen offset:1024
    buffer_load_dwordx4 v[212:215], v246, s[12:15], s29 offen offset:2048
    buffer_load_dwordx4 v[216:219], v246, s[12:15], s29 offen offset:3072
    buffer_load_dwordx4 v[220:223], v247, s[12:15], s29 offen
    buffer_load_dwordx4 v[224:227], v248, s[16:19], s30 offen
    buffer_load_dwordx4 v[228:231], v249, s[16:19], s30 offen
    buffer_load_dwordx4 v[232:235], v250, s[16:19], s30 offen
    buffer_load_dwordx4 v[236:239], v251, s[16:19], s30 offen
    s_waitcnt vmcnt(27)
    v_mfma_f32_16x16x32_bf16 v[16:19], v[96:99], v[116:119], v[16:19]
    v_mfma_f32_16x16x32_bf16 v[20:23], v[96:99], v[120:123], v[20:23]
    v_mfma_f32_16x16x32_bf16 v[24:27], v[96:99], v[124:127], v[24:27]
    v_mfma_f32_16x16x32_bf16 v[28:31], v[96:99], v[128:131], v[28:31]
    v_mfma_f32_16x16x32_bf16 v[32:35], v[100:103], v[116:119], v[32:35]
    v_mfma_f32_16x16x32_bf16 v[36:39], v[100:103], v[120:123], v[36:39]
    v_mfma_f32_16x16x32_bf16 v[40:43], v[100:103], v[124:127], v[40:43]
    v_mfma_f32_16x16x32_bf16 v[44:47], v[100:103], v[128:131], v[44:47]
    v_mfma_f32_16x16x32_bf16 v[48:51], v[104:107], v[116:119], v[48:51]
    v_mfma_f32_16x16x32_bf16 v[52:55], v[104:107], v[120:123], v[52:55]
    v_mfma_f32_16x16x32_bf16 v[56:59], v[104:107], v[124:127], v[56:59]
    v_mfma_f32_16x16x32_bf16 v[60:63], v[104:107], v[128:131], v[60:63]
    v_mfma_f32_16x16x32_bf16 v[64:67], v[108:111], v[116:119], v[64:67]
    v_mfma_f32_16x16x32_bf16 v[68:71], v[108:111], v[120:123], v[68:71]
    v_mfma_f32_16x16x32_bf16 v[72:75], v[108:111], v[124:127], v[72:75]
    v_mfma_f32_16x16x32_bf16 v[76:79], v[108:111], v[128:131], v[76:79]
    v_mfma_f32_16x16x32_bf16 v[80:83], v[112:115], v[116:119], v[80:83]
    v_mfma_f32_16x16x32_bf16 v[84:87], v[112:115], v[120:123], v[84:87]
    v_mfma_f32_16x16x32_bf16 v[88:91], v[112:115], v[124:127], v[88:91]
    v_mfma_f32_16x16x32_bf16 v[92:95], v[112:115], v[128:131], v[92:95]
    s_add_u32 s29, s27, 61440
    s_add_u32 s30, s28, 12288
    buffer_load_dwordx4 v[96:99], v246, s[12:15], s29 offen offset:0
    buffer_load_dwordx4 v[100:103], v246, s[12:15], s29 offen offset:1024
    buffer_load_dwordx4 v[104:107], v246, s[12:15], s29 offen offset:2048
    buffer_load_dwordx4 v[108:111], v246, s[12:15], s29 offen offset:3072
    buffer_load_dwordx4 v[112:115], v247, s[12:15], s29 offen
    buffer_load_dwordx4 v[116:119], v248, s[16:19], s30 offen
    buffer_load_dwordx4 v[120:123], v249, s[16:19], s30 offen
    buffer_load_dwordx4 v[124:127], v250, s[16:19], s30 offen
    buffer_load_dwordx4 v[128:131], v251, s[16:19], s30 offen
    s_waitcnt vmcnt(27)
    v_mfma_f32_16x16x32_bf16 v[16:19], v[132:135], v[152:155], v[16:19]
    v_mfma_f32_16x16x32_bf16 v[20:23], v[132:135], v[156:159], v[20:23]
    v_mfma_f32_16x16x32_bf16 v[24:27], v[132:135], v[160:163], v[24:27]
    v_mfma_f32_16x16x32_bf16 v[28:31], v[132:135], v[164:167], v[28:31]
    v_mfma_f32_16x16x32_bf16 v[32:35], v[136:139], v[152:155], v[32:35]
    v_mfma_f32_16x16x32_bf16 v[36:39], v[136:139], v[156:159], v[36:39]
    v_mfma_f32_16x16x32_bf16 v[40:43], v[136:139], v[160:163], v[40:43]
    v_mfma_f32_16x16x32_bf16 v[44:47], v[136:139], v[164:167], v[44:47]
    v_mfma_f32_16x16x32_bf16 v[48:51], v[140:143], v[152:155], v[48:51]
    v_mfma_f32_16x16x32_bf16 v[52:55], v[140:143], v[156:159], v[52:55]
    v_mfma_f32_16x16x32_bf16 v[56:59], v[140:143], v[160:163], v[56:59]
    v_mfma_f32_16x16x32_bf16 v[60:63], v[140:143], v[164:167], v[60:63]
    v_mfma_f32_16x16x32_bf16 v[64:67], v[144:147], v[152:155], v[64:67]
    v_mfma_f32_16x16x32_bf16 v[68:71], v[144:147], v[156:159], v[68:71]
    v_mfma_f32_16x16x32_bf16 v[72:75], v[144:147], v[160:163], v[72:75]
    v_mfma_f32_16x16x32_bf16 v[76:79], v[144:147], v[164:167], v[76:79]
    v_mfma_f32_16x16x32_bf16 v[80:83], v[148:151], v[152:155], v[80:83]
    v_mfma_f32_16x16x32_bf16 v[84:87], v[148:151], v[156:159], v[84:87]
    v_mfma_f32_16x16x32_bf16 v[88:91], v[148:151], v[160:163], v[88:91]
    v_mfma_f32_16x16x32_bf16 v[92:95], v[148:151], v[164:167], v[92:95]
    s_add_u32 s29, s27, 66560
    s_add_u32 s30, s28, 13312
    buffer_load_dwordx4 v[132:135], v246, s[12:15], s29 offen offset:0
    buffer_load_dwordx4 v[136:139], v246, s[12:15], s29 offen offset:1024
    buffer_load_dwordx4 v[140:143], v246, s[12:15], s29 offen offset:2048
    buffer_load_dwordx4 v[144:147], v246, s[12:15], s29 offen offset:3072
    buffer_load_dwordx4 v[148:151], v247, s[12:15], s29 offen
    buffer_load_dwordx4 v[152:155], v248, s[16:19], s30 offen
    buffer_load_dwordx4 v[156:159], v249, s[16:19], s30 offen
    buffer_load_dwordx4 v[160:163], v250, s[16:19], s30 offen
    buffer_load_dwordx4 v[164:167], v251, s[16:19], s30 offen
    s_waitcnt vmcnt(27)
    v_mfma_f32_16x16x32_bf16 v[16:19], v[168:171], v[188:191], v[16:19]
    v_mfma_f32_16x16x32_bf16 v[20:23], v[168:171], v[192:195], v[20:23]
    v_mfma_f32_16x16x32_bf16 v[24:27], v[168:171], v[196:199], v[24:27]
    v_mfma_f32_16x16x32_bf16 v[28:31], v[168:171], v[200:203], v[28:31]
    v_mfma_f32_16x16x32_bf16 v[32:35], v[172:175], v[188:191], v[32:35]
    v_mfma_f32_16x16x32_bf16 v[36:39], v[172:175], v[192:195], v[36:39]
    v_mfma_f32_16x16x32_bf16 v[40:43], v[172:175], v[196:199], v[40:43]
    v_mfma_f32_16x16x32_bf16 v[44:47], v[172:175], v[200:203], v[44:47]
    v_mfma_f32_16x16x32_bf16 v[48:51], v[176:179], v[188:191], v[48:51]
    v_mfma_f32_16x16x32_bf16 v[52:55], v[176:179], v[192:195], v[52:55]
    v_mfma_f32_16x16x32_bf16 v[56:59], v[176:179], v[196:199], v[56:59]
    v_mfma_f32_16x16x32_bf16 v[60:63], v[176:179], v[200:203], v[60:63]
    v_mfma_f32_16x16x32_bf16 v[64:67], v[180:183], v[188:191], v[64:67]
    v_mfma_f32_16x16x32_bf16 v[68:71], v[180:183], v[192:195], v[68:71]
    v_mfma_f32_16x16x32_bf16 v[72:75], v[180:183], v[196:199], v[72:75]
    v_mfma_f32_16x16x32_bf16 v[76:79], v[180:183], v[200:203], v[76:79]
    v_mfma_f32_16x16x32_bf16 v[80:83], v[184:187], v[188:191], v[80:83]
    v_mfma_f32_16x16x32_bf16 v[84:87], v[184:187], v[192:195], v[84:87]
    v_mfma_f32_16x16x32_bf16 v[88:91], v[184:187], v[196:199], v[88:91]
    v_mfma_f32_16x16x32_bf16 v[92:95], v[184:187], v[200:203], v[92:95]
    s_add_u32 s29, s27, 71680
    s_add_u32 s30, s28, 14336
    buffer_load_dwordx4 v[168:171], v246, s[12:15], s29 offen offset:0
    buffer_load_dwordx4 v[172:175], v246, s[12:15], s29 offen offset:1024
    buffer_load_dwordx4 v[176:179], v246, s[12:15], s29 offen offset:2048
    buffer_load_dwordx4 v[180:183], v246, s[12:15], s29 offen offset:3072
    buffer_load_dwordx4 v[184:187], v247, s[12:15], s29 offen
    buffer_load_dwordx4 v[188:191], v248, s[16:19], s30 offen
    buffer_load_dwordx4 v[192:195], v249, s[16:19], s30 offen
    buffer_load_dwordx4 v[196:199], v250, s[16:19], s30 offen
    buffer_load_dwordx4 v[200:203], v251, s[16:19], s30 offen
    s_waitcnt vmcnt(27)
    v_mfma_f32_16x16x32_bf16 v[16:19], v[204:207], v[224:227], v[16:19]
    v_mfma_f32_16x16x32_bf16 v[20:23], v[204:207], v[228:231], v[20:23]
    v_mfma_f32_16x16x32_bf16 v[24:27], v[204:207], v[232:235], v[24:27]
    v_mfma_f32_16x16x32_bf16 v[28:31], v[204:207], v[236:239], v[28:31]
    v_mfma_f32_16x16x32_bf16 v[32:35], v[208:211], v[224:227], v[32:35]
    v_mfma_f32_16x16x32_bf16 v[36:39], v[208:211], v[228:231], v[36:39]
    v_mfma_f32_16x16x32_bf16 v[40:43], v[208:211], v[232:235], v[40:43]
    v_mfma_f32_16x16x32_bf16 v[44:47], v[208:211], v[236:239], v[44:47]
    v_mfma_f32_16x16x32_bf16 v[48:51], v[212:215], v[224:227], v[48:51]
    v_mfma_f32_16x16x32_bf16 v[52:55], v[212:215], v[228:231], v[52:55]
    v_mfma_f32_16x16x32_bf16 v[56:59], v[212:215], v[232:235], v[56:59]
    v_mfma_f32_16x16x32_bf16 v[60:63], v[212:215], v[236:239], v[60:63]
    v_mfma_f32_16x16x32_bf16 v[64:67], v[216:219], v[224:227], v[64:67]
    v_mfma_f32_16x16x32_bf16 v[68:71], v[216:219], v[228:231], v[68:71]
    v_mfma_f32_16x16x32_bf16 v[72:75], v[216:219], v[232:235], v[72:75]
    v_mfma_f32_16x16x32_bf16 v[76:79], v[216:219], v[236:239], v[76:79]
    v_mfma_f32_16x16x32_bf16 v[80:83], v[220:223], v[224:227], v[80:83]
    v_mfma_f32_16x16x32_bf16 v[84:87], v[220:223], v[228:231], v[84:87]
    v_mfma_f32_16x16x32_bf16 v[88:91], v[220:223], v[232:235], v[88:91]
    v_mfma_f32_16x16x32_bf16 v[92:95], v[220:223], v[236:239], v[92:95]
    s_add_u32 s29, s27, 76800
    s_add_u32 s30, s28, 15360
    buffer_load_dwordx4 v[204:207], v246, s[12:15], s29 offen offset:0
    buffer_load_dwordx4 v[208:211], v246, s[12:15], s29 offen offset:1024
    buffer_load_dwordx4 v[212:215], v246, s[12:15], s29 offen offset:2048
    buffer_load_dwordx4 v[216:219], v246, s[12:15], s29 offen offset:3072
    buffer_load_dwordx4 v[220:223], v247, s[12:15], s29 offen
    buffer_load_dwordx4 v[224:227], v248, s[16:19], s30 offen
    buffer_load_dwordx4 v[228:231], v249, s[16:19], s30 offen
    buffer_load_dwordx4 v[232:235], v250, s[16:19], s30 offen
    buffer_load_dwordx4 v[236:239], v251, s[16:19], s30 offen
    s_waitcnt vmcnt(27)
    v_mfma_f32_16x16x32_bf16 v[16:19], v[96:99], v[116:119], v[16:19]
    v_mfma_f32_16x16x32_bf16 v[20:23], v[96:99], v[120:123], v[20:23]
    v_mfma_f32_16x16x32_bf16 v[24:27], v[96:99], v[124:127], v[24:27]
    v_mfma_f32_16x16x32_bf16 v[28:31], v[96:99], v[128:131], v[28:31]
    v_mfma_f32_16x16x32_bf16 v[32:35], v[100:103], v[116:119], v[32:35]
    v_mfma_f32_16x16x32_bf16 v[36:39], v[100:103], v[120:123], v[36:39]
    v_mfma_f32_16x16x32_bf16 v[40:43], v[100:103], v[124:127], v[40:43]
    v_mfma_f32_16x16x32_bf16 v[44:47], v[100:103], v[128:131], v[44:47]
    v_mfma_f32_16x16x32_bf16 v[48:51], v[104:107], v[116:119], v[48:51]
    v_mfma_f32_16x16x32_bf16 v[52:55], v[104:107], v[120:123], v[52:55]
    v_mfma_f32_16x16x32_bf16 v[56:59], v[104:107], v[124:127], v[56:59]
    v_mfma_f32_16x16x32_bf16 v[60:63], v[104:107], v[128:131], v[60:63]
    v_mfma_f32_16x16x32_bf16 v[64:67], v[108:111], v[116:119], v[64:67]
    v_mfma_f32_16x16x32_bf16 v[68:71], v[108:111], v[120:123], v[68:71]
    v_mfma_f32_16x16x32_bf16 v[72:75], v[108:111], v[124:127], v[72:75]
    v_mfma_f32_16x16x32_bf16 v[76:79], v[108:111], v[128:131], v[76:79]
    v_mfma_f32_16x16x32_bf16 v[80:83], v[112:115], v[116:119], v[80:83]
    v_mfma_f32_16x16x32_bf16 v[84:87], v[112:115], v[120:123], v[84:87]
    v_mfma_f32_16x16x32_bf16 v[88:91], v[112:115], v[124:127], v[88:91]
    v_mfma_f32_16x16x32_bf16 v[92:95], v[112:115], v[128:131], v[92:95]
    s_waitcnt vmcnt(18)
    v_mfma_f32_16x16x32_bf16 v[16:19], v[132:135], v[152:155], v[16:19]
    v_mfma_f32_16x16x32_bf16 v[20:23], v[132:135], v[156:159], v[20:23]
    v_mfma_f32_16x16x32_bf16 v[24:27], v[132:135], v[160:163], v[24:27]
    v_mfma_f32_16x16x32_bf16 v[28:31], v[132:135], v[164:167], v[28:31]
    v_mfma_f32_16x16x32_bf16 v[32:35], v[136:139], v[152:155], v[32:35]
    v_mfma_f32_16x16x32_bf16 v[36:39], v[136:139], v[156:159], v[36:39]
    v_mfma_f32_16x16x32_bf16 v[40:43], v[136:139], v[160:163], v[40:43]
    v_mfma_f32_16x16x32_bf16 v[44:47], v[136:139], v[164:167], v[44:47]
    v_mfma_f32_16x16x32_bf16 v[48:51], v[140:143], v[152:155], v[48:51]
    v_mfma_f32_16x16x32_bf16 v[52:55], v[140:143], v[156:159], v[52:55]
    v_mfma_f32_16x16x32_bf16 v[56:59], v[140:143], v[160:163], v[56:59]
    v_mfma_f32_16x16x32_bf16 v[60:63], v[140:143], v[164:167], v[60:63]
    v_mfma_f32_16x16x32_bf16 v[64:67], v[144:147], v[152:155], v[64:67]
    v_mfma_f32_16x16x32_bf16 v[68:71], v[144:147], v[156:159], v[68:71]
    v_mfma_f32_16x16x32_bf16 v[72:75], v[144:147], v[160:163], v[72:75]
    v_mfma_f32_16x16x32_bf16 v[76:79], v[144:147], v[164:167], v[76:79]
    v_mfma_f32_16x16x32_bf16 v[80:83], v[148:151], v[152:155], v[80:83]
    v_mfma_f32_16x16x32_bf16 v[84:87], v[148:151], v[156:159], v[84:87]
    v_mfma_f32_16x16x32_bf16 v[88:91], v[148:151], v[160:163], v[88:91]
    v_mfma_f32_16x16x32_bf16 v[92:95], v[148:151], v[164:167], v[92:95]
    s_waitcnt vmcnt(9)
    v_mfma_f32_16x16x32_bf16 v[16:19], v[168:171], v[188:191], v[16:19]
    v_mfma_f32_16x16x32_bf16 v[20:23], v[168:171], v[192:195], v[20:23]
    v_mfma_f32_16x16x32_bf16 v[24:27], v[168:171], v[196:199], v[24:27]
    v_mfma_f32_16x16x32_bf16 v[28:31], v[168:171], v[200:203], v[28:31]
    v_mfma_f32_16x16x32_bf16 v[32:35], v[172:175], v[188:191], v[32:35]
    v_mfma_f32_16x16x32_bf16 v[36:39], v[172:175], v[192:195], v[36:39]
    v_mfma_f32_16x16x32_bf16 v[40:43], v[172:175], v[196:199], v[40:43]
    v_mfma_f32_16x16x32_bf16 v[44:47], v[172:175], v[200:203], v[44:47]
    v_mfma_f32_16x16x32_bf16 v[48:51], v[176:179], v[188:191], v[48:51]
    v_mfma_f32_16x16x32_bf16 v[52:55], v[176:179], v[192:195], v[52:55]
    v_mfma_f32_16x16x32_bf16 v[56:59], v[176:179], v[196:199], v[56:59]
    v_mfma_f32_16x16x32_bf16 v[60:63], v[176:179], v[200:203], v[60:63]
    v_mfma_f32_16x16x32_bf16 v[64:67], v[180:183], v[188:191], v[64:67]
    v_mfma_f32_16x16x32_bf16 v[68:71], v[180:183], v[192:195], v[68:71]
    v_mfma_f32_16x16x32_bf16 v[72:75], v[180:183], v[196:199], v[72:75]
    v_mfma_f32_16x16x32_bf16 v[76:79], v[180:183], v[200:203], v[76:79]
    v_mfma_f32_16x16x32_bf16 v[80:83], v[184:187], v[188:191], v[80:83]
    v_mfma_f32_16x16x32_bf16 v[84:87], v[184:187], v[192:195], v[84:87]
    v_mfma_f32_16x16x32_bf16 v[88:91], v[184:187], v[196:199], v[88:91]
    v_mfma_f32_16x16x32_bf16 v[92:95], v[184:187], v[200:203], v[92:95]
    s_waitcnt vmcnt(0)
    v_mfma_f32_16x16x32_bf16 v[16:19], v[204:207], v[224:227], v[16:19]
    v_mfma_f32_16x16x32_bf16 v[20:23], v[204:207], v[228:231], v[20:23]
    v_mfma_f32_16x16x32_bf16 v[24:27], v[204:207], v[232:235], v[24:27]
    v_mfma_f32_16x16x32_bf16 v[28:31], v[204:207], v[236:239], v[28:31]
    v_mfma_f32_16x16x32_bf16 v[32:35], v[208:211], v[224:227], v[32:35]
    v_mfma_f32_16x16x32_bf16 v[36:39], v[208:211], v[228:231], v[36:39]
    v_mfma_f32_16x16x32_bf16 v[40:43], v[208:211], v[232:235], v[40:43]
    v_mfma_f32_16x16x32_bf16 v[44:47], v[208:211], v[236:239], v[44:47]
    v_mfma_f32_16x16x32_bf16 v[48:51], v[212:215], v[224:227], v[48:51]
    v_mfma_f32_16x16x32_bf16 v[52:55], v[212:215], v[228:231], v[52:55]
    v_mfma_f32_16x16x32_bf16 v[56:59], v[212:215], v[232:235], v[56:59]
    v_mfma_f32_16x16x32_bf16 v[60:63], v[212:215], v[236:239], v[60:63]
    v_mfma_f32_16x16x32_bf16 v[64:67], v[216:219], v[224:227], v[64:67]
    v_mfma_f32_16x16x32_bf16 v[68:71], v[216:219], v[228:231], v[68:71]
    v_mfma_f32_16x16x32_bf16 v[72:75], v[216:219], v[232:235], v[72:75]
    v_mfma_f32_16x16x32_bf16 v[76:79], v[216:219], v[236:239], v[76:79]
    v_mfma_f32_16x16x32_bf16 v[80:83], v[220:223], v[224:227], v[80:83]
    v_mfma_f32_16x16x32_bf16 v[84:87], v[220:223], v[228:231], v[84:87]
    v_mfma_f32_16x16x32_bf16 v[88:91], v[220:223], v[232:235], v[88:91]
    v_mfma_f32_16x16x32_bf16 v[92:95], v[220:223], v[236:239], v[92:95]
    s_mul_i32 s27, s24, 20480
    v_add_u32 v11, s27, v246
    ds_write_b128 v11, v[16:19] offset:0
    ds_write_b128 v11, v[20:23] offset:1024
    ds_write_b128 v11, v[24:27] offset:2048
    ds_write_b128 v11, v[28:31] offset:3072
    ds_write_b128 v11, v[32:35] offset:4096
    ds_write_b128 v11, v[36:39] offset:5120
    ds_write_b128 v11, v[40:43] offset:6144
    ds_write_b128 v11, v[44:47] offset:7168
    ds_write_b128 v11, v[48:51] offset:8192
    ds_write_b128 v11, v[52:55] offset:9216
    ds_write_b128 v11, v[56:59] offset:10240
    ds_write_b128 v11, v[60:63] offset:11264
    s_waitcnt lgkmcnt(0)
    ds_write_b128 v11, v[64:67] offset:12288
    ds_write_b128 v11, v[68:71] offset:13312
    ds_write_b128 v11, v[72:75] offset:14336
    ds_write_b128 v11, v[76:79] offset:15360
    ds_write_b128 v11, v[80:83] offset:16384
    ds_write_b128 v11, v[84:87] offset:17408
    ds_write_b128 v11, v[88:91] offset:18432
    ds_write_b128 v11, v[92:95] offset:19456
    s_waitcnt lgkmcnt(0)
    s_barrier
    s_lshl_b32 s29, s24, 10
    v_add_u32 v10, s29, v246
    v_add_u32 v11, s29, v246
    v_add_u32 v11, 61440, v11
    v_add_u32 v12, s29, v246
    v_add_u32 v12, 122880, v12
    v_and_b32 v13, 3, v2
    v_lshl_add_u32 v13, v13, 4, v4
    v_mul_u32_u24 v13, 0xa00, v13
    v_lshl_add_u32 v13, v3, 3, v13
    v_lshrrev_b32 v14, 2, v2
    v_lshl_add_u32 v252, v14, 5, v13
    ds_read_b128 v[96:99], v10 offset:0
    ds_read_b128 v[100:103], v10 offset:20480
    ds_read_b128 v[104:107], v10 offset:40960
    ds_read_b128 v[108:111], v11 offset:0
    ds_read_b128 v[112:115], v11 offset:20480
    ds_read_b128 v[116:119], v11 offset:40960
    ds_read_b128 v[120:123], v12 offset:0
    ds_read_b128 v[124:127], v12 offset:20480
    s_waitcnt lgkmcnt(0)
    v_add_f32 v96, v96, v112
    v_add_f32 v97, v97, v113
    v_add_f32 v98, v98, v114
    v_add_f32 v99, v99, v115
    v_add_f32 v100, v100, v116
    v_add_f32 v101, v101, v117
    v_add_f32 v102, v102, v118
    v_add_f32 v103, v103, v119
    v_add_f32 v104, v104, v120
    v_add_f32 v105, v105, v121
    v_add_f32 v106, v106, v122
    v_add_f32 v107, v107, v123
    v_add_f32 v108, v108, v124
    v_add_f32 v109, v109, v125
    v_add_f32 v110, v110, v126
    v_add_f32 v111, v111, v127
    v_add_f32 v96, v96, v104
    v_add_f32 v97, v97, v105
    v_add_f32 v98, v98, v106
    v_add_f32 v99, v99, v107
    v_add_f32 v100, v100, v108
    v_add_f32 v101, v101, v109
    v_add_f32 v102, v102, v110
    v_add_f32 v103, v103, v111
    v_add_f32 v96, v96, v100
    v_add_f32 v97, v97, v101
    v_add_f32 v98, v98, v102
    v_add_f32 v99, v99, v103
    v_cvt_pk_bf16_f32 v100, v96, v97
    v_cvt_pk_bf16_f32 v101, v98, v99
    buffer_store_dwordx2 v[100:101], v252, s[20:23], 0 offen offset:0
    ds_read_b128 v[128:131], v10 offset:8192
    ds_read_b128 v[132:135], v10 offset:28672
    ds_read_b128 v[136:139], v10 offset:49152
    ds_read_b128 v[140:143], v11 offset:8192
    ds_read_b128 v[144:147], v11 offset:28672
    ds_read_b128 v[148:151], v11 offset:49152
    ds_read_b128 v[152:155], v12 offset:8192
    ds_read_b128 v[156:159], v12 offset:28672
    s_waitcnt lgkmcnt(0)
    v_add_f32 v128, v128, v144
    v_add_f32 v129, v129, v145
    v_add_f32 v130, v130, v146
    v_add_f32 v131, v131, v147
    v_add_f32 v132, v132, v148
    v_add_f32 v133, v133, v149
    v_add_f32 v134, v134, v150
    v_add_f32 v135, v135, v151
    v_add_f32 v136, v136, v152
    v_add_f32 v137, v137, v153
    v_add_f32 v138, v138, v154
    v_add_f32 v139, v139, v155
    v_add_f32 v140, v140, v156
    v_add_f32 v141, v141, v157
    v_add_f32 v142, v142, v158
    v_add_f32 v143, v143, v159
    v_add_f32 v128, v128, v136
    v_add_f32 v129, v129, v137
    v_add_f32 v130, v130, v138
    v_add_f32 v131, v131, v139
    v_add_f32 v132, v132, v140
    v_add_f32 v133, v133, v141
    v_add_f32 v134, v134, v142
    v_add_f32 v135, v135, v143
    v_add_f32 v128, v128, v132
    v_add_f32 v129, v129, v133
    v_add_f32 v130, v130, v134
    v_add_f32 v131, v131, v135
    v_cvt_pk_bf16_f32 v132, v128, v129
    v_cvt_pk_bf16_f32 v133, v130, v131
    buffer_store_dwordx2 v[132:133], v252, s[20:23], 0 offen offset:64
    s_cmp_ge_u32 s24, 4
    s_cbranch_scc1 RS_1
    ds_read_b128 v[160:163], v10 offset:16384
    ds_read_b128 v[164:167], v10 offset:36864
    ds_read_b128 v[168:171], v10 offset:57344
    ds_read_b128 v[172:175], v11 offset:16384
    ds_read_b128 v[176:179], v11 offset:36864
    ds_read_b128 v[180:183], v11 offset:57344
    ds_read_b128 v[184:187], v12 offset:16384
    ds_read_b128 v[188:191], v12 offset:36864
    s_waitcnt lgkmcnt(0)
    v_add_f32 v160, v160, v176
    v_add_f32 v161, v161, v177
    v_add_f32 v162, v162, v178
    v_add_f32 v163, v163, v179
    v_add_f32 v164, v164, v180
    v_add_f32 v165, v165, v181
    v_add_f32 v166, v166, v182
    v_add_f32 v167, v167, v183
    v_add_f32 v168, v168, v184
    v_add_f32 v169, v169, v185
    v_add_f32 v170, v170, v186
    v_add_f32 v171, v171, v187
    v_add_f32 v172, v172, v188
    v_add_f32 v173, v173, v189
    v_add_f32 v174, v174, v190
    v_add_f32 v175, v175, v191
    v_add_f32 v160, v160, v168
    v_add_f32 v161, v161, v169
    v_add_f32 v162, v162, v170
    v_add_f32 v163, v163, v171
    v_add_f32 v164, v164, v172
    v_add_f32 v165, v165, v173
    v_add_f32 v166, v166, v174
    v_add_f32 v167, v167, v175
    v_add_f32 v160, v160, v164
    v_add_f32 v161, v161, v165
    v_add_f32 v162, v162, v166
    v_add_f32 v163, v163, v167
    v_cvt_pk_bf16_f32 v164, v160, v161
    v_cvt_pk_bf16_f32 v165, v162, v163
    buffer_store_dwordx2 v[164:165], v252, s[20:23], 0 offen offset:128
RS_1:
oproj_done:
    s_endpgm
.section .rodata,"a"
.p2align 6
.amdhsa_kernel attn_kernel
  .amdhsa_next_free_vgpr 256
  .amdhsa_next_free_sgpr 102
  .amdhsa_accum_offset 256
  .amdhsa_group_segment_fixed_size 0
  .amdhsa_kernarg_size 104
  .amdhsa_user_sgpr_count 2
  .amdhsa_user_sgpr_kernarg_segment_ptr 1
  .amdhsa_system_sgpr_workgroup_id_x 1
.end_amdhsa_kernel
.p2align 6
.amdhsa_kernel oproj_kernel
  .amdhsa_next_free_vgpr 256
  .amdhsa_next_free_sgpr 102
  .amdhsa_accum_offset 256
  .amdhsa_group_segment_fixed_size 0
  .amdhsa_kernarg_size 104
  .amdhsa_user_sgpr_count 2
  .amdhsa_user_sgpr_kernarg_segment_ptr 1
  .amdhsa_system_sgpr_workgroup_id_x 1
.end_amdhsa_kernel
```
